```python
import torch

def _softmax(x, axis=-1):
    return torch.softmax(x, dim=axis)
def _gelu(x):
    return torch.nn.functional.gelu(x, approximate="tanh")
def _silu(x):
    return torch.nn.functional.silu(x)
def _sigmoid(x):
    return torch.sigmoid(x)
def _layernorm(x, axis=-1, eps=1e-5):
    m = x.mean(dim=axis, keepdim=True)
    v = x.var(dim=axis, keepdim=True, unbiased=False)
    return (x - m) / torch.sqrt(v + eps)
def _scatter_add(tgt, idx, src, axis=0):
    return tgt.clone().index_add_(axis, idx, src)
def _segment_sum(src, seg, n):
    out = torch.zeros((n,) + src.shape[1:], dtype=src.dtype)
    return out.index_add_(0, seg, src)
def _pad(x, pw):
    flat = tuple(v for pair in reversed(pw) for v in pair)
    return torch.nn.functional.pad(x, flat)

kernel_name = 'standalone__gqa_softmax__near_ridge'

def setup_inputs():

    _w = (lambda a: (lambda t: t.to(torch.bfloat16) if t.is_floating_point() else t)(torch.as_tensor(a)))
    B, Hq, Hkv, Sq, Sk, D = 8, 32, 4, 256, 256, 128
    return {
        "q": _w((lambda *s: torch.randn(*s, dtype=torch.bfloat16) * 0.8)(B, Hq, Sq, D)),
        "k": _w((lambda *s: torch.randn(*s, dtype=torch.bfloat16) * 0.8)(B, Hkv, Sk, D)),
        "v": _w((lambda *s: torch.randn(*s, dtype=torch.bfloat16) * 0.05)(B, Hkv, Sk, D)),
    }

def reference(q, k, v):
    B, Hq, Sq, D = q.shape
    Hkv = k.shape[1]
    rep = Hq // Hkv
    k = (lambda x, n, axis: torch.repeat_interleave(x, n, dim=axis))(k, rep, axis=1)
    v = (lambda x, n, axis: torch.repeat_interleave(x, n, dim=axis))(v, rep, axis=1)
    scale = D ** -0.5
    scores = torch.einsum("bhqd,bhkd->bhqk", q, k) * scale
    p = _softmax(scores, axis=-1)
    return torch.einsum("bhqk,bhkd->bhqd", p, v)
```

```asm
; @launch grid=(256,1,1) block=(512,1,1) lds=163840
.amdgcn_target "amdgcn-amd-amdhsa--gfx950"
.text
.globl standalone__gqa_softmax__near_ridge_kernel
.p2align 8
.type standalone__gqa_softmax__near_ridge_kernel,@function
standalone__gqa_softmax__near_ridge_kernel:
    s_cmp_ge_u32 s2, 256
    s_cbranch_scc1 L_end
    s_load_dwordx4 s[4:7], s[0:1], 0
    s_load_dwordx4 s[8:11], s[0:1], 16
    v_lshrrev_b32 v1, 6, v0
    v_and_b32 v0, 63, v0
    s_lshr_b32 s15, s2, 3
    v_readfirstlane_b32 s3, v1
    s_getpc_b64 s[18:19]
    s_lshl_b32 s32, s15, 9
    s_add_u32 s18, s18, s32
    s_addc_u32 s19, s19, 0
    v_and_b32 v2, 3, v0
    v_lshlrev_b32 v2, 7, v2
    global_load_dword v1, v2, s[18:19]
    s_and_b32 s14, s2, 7
    s_lshr_b32 s32, s15, 3
    s_lshl_b32 s14, s14, 2
    s_add_u32 s14, s14, s32
    s_and_b32 s15, s15, 7
    s_lshl_b32 s32, s14, 3
    s_add_u32 s15, s15, s32
    s_lshl_b32 s14, s14, 16
    s_lshl_b32 s15, s15, 16
    v_lshrrev_b32 v2, 4, v0
    s_lshl_b32 s34, s3, 13
    s_cmp_ge_u32 s3, 4
    s_cbranch_scc1 L_B
    s_add_u32 s35, s34, 0x20000
    s_add_u32 s37, s34, 128
    s_mov_b32 s18, 0x10000
    s_mov_b32 s19, 0x20000
    s_cmp_ge_u32 s3, 2
    s_cbranch_scc1 L_lag
    v_and_b32 v3, 7, v0
    v_xor_b32 v3, v2, v3
    v_lshlrev_b32 v3, 4, v3
    v_lshrrev_b32 v4, 3, v0
    v_lshl_add_u32 v36, v4, 8, v3
    v_xor_b32 v3, 64, v36
    v_add_u32 v38, 0x800, v36
    v_add_u32 v37, 0x400, v3
    v_add_u32 v39, 0xc00, v3
    s_mov_b32 m0, s35
    s_waitcnt lgkmcnt(0)
    s_add_u32 s16, s4, s15
    s_addc_u32 s17, s5, 0
    buffer_load_dwordx4 v36, s[16:19], s34 offen offset:0  lds
    buffer_load_dwordx4 v37, s[16:19], s34 offen offset:1024  lds
    buffer_load_dwordx4 v38, s[16:19], s34 offen offset:2048  lds
    buffer_load_dwordx4 v39, s[16:19], s34 offen offset:3072  lds
    s_add_u32 m0, s35, 4096
    s_nop 0
    buffer_load_dwordx4 v36, s[16:19], s37 offen offset:0  lds
    buffer_load_dwordx4 v37, s[16:19], s37 offen offset:1024  lds
    buffer_load_dwordx4 v38, s[16:19], s37 offen offset:2048  lds
    buffer_load_dwordx4 v39, s[16:19], s37 offen offset:3072  lds
    s_branch L_A
L_lag:
    v_and_b32 v3, 15, v0
    v_xor_b32 v4, v2, v3
    v_lshlrev_b32 v4, 4, v4
    v_lshl_add_u32 v40, v2, 8, v4
    v_xor_b32 v41, 64, v40
    v_xor_b32 v42, 128, v40
    v_xor_b32 v43, 192, v40
    s_mov_b32 s22, 0x10000
    s_mov_b32 s23, 0x20000
    s_sub_u32 s33, s3, 2
    s_lshl_b32 s33, s33, 12
    s_mov_b32 m0, s33
    s_waitcnt lgkmcnt(0)
    s_add_u32 s20, s6, s14
    s_addc_u32 s21, s7, 0
    buffer_load_dwordx4 v40, s[20:23], s33 offen offset:0  lds
    buffer_load_dwordx4 v41, s[20:23], s33 offen offset:1024  lds
    buffer_load_dwordx4 v42, s[20:23], s33 offen offset:2048  lds
    buffer_load_dwordx4 v43, s[20:23], s33 offen offset:3072  lds
    s_add_u32 s16, s4, s15
    s_addc_u32 s17, s5, 0
    s_mov_b32 m0, s35
    v_and_b32 v3, 7, v0
    v_xor_b32 v3, v2, v3
    v_lshlrev_b32 v3, 4, v3
    v_lshrrev_b32 v4, 3, v0
    v_lshl_add_u32 v36, v4, 8, v3
    v_xor_b32 v3, 64, v36
    v_add_u32 v38, 0x800, v36
    v_add_u32 v37, 0x400, v3
    v_add_u32 v39, 0xc00, v3
    s_waitcnt vmcnt(0)
    buffer_load_dwordx4 v36, s[16:19], s34 offen offset:0  lds
    buffer_load_dwordx4 v37, s[16:19], s34 offen offset:1024  lds
    buffer_load_dwordx4 v38, s[16:19], s34 offen offset:2048  lds
    buffer_load_dwordx4 v39, s[16:19], s34 offen offset:3072  lds
    s_add_u32 m0, s35, 4096
    s_nop 0
    buffer_load_dwordx4 v36, s[16:19], s37 offen offset:0  lds
    buffer_load_dwordx4 v37, s[16:19], s37 offen offset:1024  lds
    buffer_load_dwordx4 v38, s[16:19], s37 offen offset:2048  lds
    buffer_load_dwordx4 v39, s[16:19], s37 offen offset:3072  lds
    s_branch L_A
L_B:
    v_and_b32 v3, 15, v0
    v_xor_b32 v4, v2, v3
    v_lshlrev_b32 v4, 4, v4
    v_lshl_add_u32 v40, v2, 8, v4
    s_and_b32 s32, s3, 1
    s_lshl_b32 s32, s32, 7
    v_xor_b32 v40, s32, v40
    v_xor_b32 v41, 64, v40
    s_and_b32 s36, s3, 3
    s_lshl_b32 s35, s36, 13
    s_add_u32 s35, s35, 0x21000
    s_lshl_b32 s36, s36, 11
    s_mov_b32 s22, 0x10000
    s_mov_b32 s23, 0x20000
    s_waitcnt lgkmcnt(0)
    s_add_u32 s20, s6, s14
    s_addc_u32 s21, s7, 0
    s_add_u32 m0, s36, 8192
    s_add_u32 s32, s36, 8192
    buffer_load_dwordx4 v40, s[20:23], s32 offen offset:0  lds
    buffer_load_dwordx4 v41, s[20:23], s32 offen offset:1024  lds
    s_add_u32 m0, s36, 16384
    s_add_u32 s32, s36, 16384
    buffer_load_dwordx4 v40, s[20:23], s32 offen offset:0  lds
    buffer_load_dwordx4 v41, s[20:23], s32 offen offset:1024  lds
    s_add_u32 m0, s36, 24576
    s_add_u32 s32, s36, 24576
    buffer_load_dwordx4 v40, s[20:23], s32 offen offset:0  lds
    buffer_load_dwordx4 v41, s[20:23], s32 offen offset:1024  lds
    s_add_u32 s24, s8, s14
    s_addc_u32 s25, s9, 0
    s_mov_b32 s26, 0x10000
    s_mov_b32 s27, 0x20000
    v_lshlrev_b32 v5, 2, v2
    v_and_b32 v3, 15, v0
    v_xor_b32 v5, v5, v3
    v_lshlrev_b32 v5, 4, v5
    v_lshl_add_u32 v7, v2, 8, v5
    s_add_u32 s16, s4, s15
    s_addc_u32 s17, s5, 0
    s_mov_b32 s18, 0x10000
    s_mov_b32 s19, 0x20000
    v_and_b32 v3, 7, v0
    v_xor_b32 v3, v2, v3
    v_lshlrev_b32 v3, 4, v3
    v_lshrrev_b32 v4, 3, v0
    v_lshl_add_u32 v36, v4, 8, v3
    v_xor_b32 v3, 64, v36
    v_add_u32 v38, 0x800, v36
    v_add_u32 v37, 0x400, v3
    v_add_u32 v39, 0xc00, v3
    s_add_u32 s28, s10, s15
    s_addc_u32 s29, s11, 0
    s_mov_b32 s30, 0x10000
    s_mov_b32 s31, 0x20000
    v_and_b32 v2, 31, v0
    v_lshrrev_b32 v3, 5, v0
    v_and_b32 v4, 15, v0
    v_xor_b32 v4, v4, v3
    v_lshlrev_b32 v4, 4, v4
    v_lshl_add_u32 v8, v2, 8, v4
    v_xor_b32 v9, 32, v8
    v_xor_b32 v10, 64, v8
    v_xor_b32 v11, 96, v8
    v_xor_b32 v12, 128, v8
    v_xor_b32 v13, 160, v8
    v_xor_b32 v14, 192, v8
    v_xor_b32 v15, 224, v8
    v_bfe_u32 v4, v0, 1, 3
    v_xor_b32 v4, v4, v3
    v_lshlrev_b32 v4, 4, v4
    v_lshl_add_u32 v4, v2, 7, v4
    v_add_u32 v20, s35, v4
    v_xor_b32 v21, 32, v20
    v_xor_b32 v22, 64, v20
    v_xor_b32 v23, 96, v20
    v_bfe_u32 v4, v0, 2, 2
    v_lshl_add_u32 v5, v3, 2, v4
    v_lshlrev_b32 v5, 8, v5
    v_lshl_add_u32 v5, v4, 6, v5
    v_bfe_u32 v6, v0, 4, 1
    v_lshl_add_u32 v5, v6, 5, v5
    v_and_b32 v6, 1, v0
    v_lshl_add_u32 v5, v6, 4, v5
    v_bfe_u32 v6, v0, 1, 1
    v_lshl_add_u32 v5, v6, 3, v5
    v_add_u32 v16, 0x10000, v5
    v_xor_b32 v17, 64, v16
    v_xor_b32 v18, 128, v16
    v_xor_b32 v19, 192, v16
    v_and_b32 v4, 7, v0
    v_xor_b32 v4, v4, v3
    v_lshlrev_b32 v4, 4, v4
    v_lshl_add_u32 v4, v2, 7, v4
    v_add_u32 v24, s35, v4
    v_lshrrev_b32 v4, 3, v0
    v_and_b32 v5, 7, v0
    v_xor_b32 v6, v4, v5
    v_lshlrev_b32 v6, 4, v6
    v_lshl_add_u32 v6, v4, 7, v6
    v_add_u32 v26, s35, v6
    v_lshlrev_b32 v5, 4, v5
    v_lshl_add_u32 v5, v4, 8, v5
    v_add_u32 v27, s34, v5
    s_mov_b32 s92, 0
    s_mov_b32 s93, 2048
    s_mov_b32 s94, 4096
    s_mov_b32 s95, 6144
    v_mov_b32 v31, 0x3e0293ee
    v_mov_b32 v34, 0xff800000
    v_mov_b32 v6, 0x4e800000
    v_lshrrev_b32 v4, 4, v0
    v_lshrrev_b32 v5, 2, v0
    v_xor_b32 v4, v4, v5
    v_and_b32 v4, 1, v4
    v_sub_u32 v4, v4, 1
    v_and_b32 v248, 0x3f803f80, v4
    v_and_b32 v249, 0x3f803f80, v4
    v_and_b32 v250, 0x3f803f80, v4
    v_and_b32 v251, 0x3f803f80, v4
    s_mov_b64 s[96:97], -1
    s_barrier
    s_add_u32 m0, s36, 32768
    s_add_u32 s32, s36, 32768
    buffer_load_dwordx4 v40, s[20:23], s32 offen offset:0  lds
    buffer_load_dwordx4 v41, s[20:23], s32 offen offset:1024  lds
    s_add_u32 m0, s36, 40960
    s_add_u32 s32, s36, 40960
    buffer_load_dwordx4 v40, s[20:23], s32 offen offset:0  lds
    buffer_load_dwordx4 v41, s[20:23], s32 offen offset:1024  lds
    s_add_u32 m0, s36, 49152
    s_add_u32 s32, s36, 49152
    buffer_load_dwordx4 v40, s[20:23], s32 offen offset:0  lds
    buffer_load_dwordx4 v41, s[20:23], s32 offen offset:1024  lds
    s_waitcnt vmcnt(10)
    s_barrier
    s_add_u32 m0, s36, 57344
    s_add_u32 s32, s36, 57344
    buffer_load_dwordx4 v40, s[20:23], s32 offen offset:0  lds
    buffer_load_dwordx4 v41, s[20:23], s32 offen offset:1024  lds
    s_waitcnt vmcnt(8)
    s_barrier
    s_waitcnt vmcnt(0)
    s_barrier
    s_lshr_b32 s38, s15, 3
    s_and_b32 s38, s38, 0xe000
    s_add_u32 s38, s38, s36
    s_add_u32 m0, s38, 0x10000
    s_nop 0
    buffer_load_dwordx4 v7, s[24:27], s38 offen offset:0  lds
    buffer_load_dwordx4 v7, s[24:27], s38 offen offset:1024  lds
    s_add_u32 s38, s38, 8192
    s_and_b32 s38, s38, 0xffff
    s_add_u32 m0, s38, 0x10000
    s_nop 0
    buffer_load_dwordx4 v7, s[24:27], s38 offen offset:0  lds
    buffer_load_dwordx4 v7, s[24:27], s38 offen offset:1024  lds
    s_add_u32 s38, s38, 8192
    s_and_b32 s38, s38, 0xffff
    s_add_u32 m0, s38, 0x10000
    s_nop 0
    buffer_load_dwordx4 v7, s[24:27], s38 offen offset:0  lds
    buffer_load_dwordx4 v7, s[24:27], s38 offen offset:1024  lds
    s_add_u32 s38, s38, 8192
    s_and_b32 s38, s38, 0xffff
    s_add_u32 m0, s38, 0x10000
    s_nop 0
    buffer_load_dwordx4 v7, s[24:27], s38 offen offset:0  lds
    buffer_load_dwordx4 v7, s[24:27], s38 offen offset:1024  lds
    s_add_u32 s38, s38, 8192
    s_and_b32 s38, s38, 0xffff
    s_add_u32 m0, s38, 0x10000
    s_nop 0
    buffer_load_dwordx4 v7, s[24:27], s38 offen offset:0  lds
    buffer_load_dwordx4 v7, s[24:27], s38 offen offset:1024  lds
    s_add_u32 s38, s38, 8192
    s_and_b32 s38, s38, 0xffff
    s_add_u32 m0, s38, 0x10000
    s_nop 0
    buffer_load_dwordx4 v7, s[24:27], s38 offen offset:0  lds
    buffer_load_dwordx4 v7, s[24:27], s38 offen offset:1024  lds
    s_add_u32 s38, s38, 8192
    s_and_b32 s38, s38, 0xffff
    s_add_u32 m0, s38, 0x10000
    s_nop 0
    buffer_load_dwordx4 v7, s[24:27], s38 offen offset:0  lds
    buffer_load_dwordx4 v7, s[24:27], s38 offen offset:1024  lds
    s_add_u32 s38, s38, 8192
    s_and_b32 s38, s38, 0xffff
    s_add_u32 m0, s38, 0x10000
    s_nop 0
    buffer_load_dwordx4 v7, s[24:27], s38 offen offset:0  lds
    buffer_load_dwordx4 v7, s[24:27], s38 offen offset:1024  lds
    s_waitcnt vmcnt(0)
    s_barrier
    s_bitcmp1_b32 s3, 1
    s_cbranch_scc0 L_t6a
    s_barrier
L_t6a:
    s_mov_b32 m0, s35
    s_nop 0
    buffer_load_dwordx4 v36, s[16:19], s34 offen offset:0  lds
    buffer_load_dwordx4 v37, s[16:19], s34 offen offset:1024  lds
    buffer_load_dwordx4 v38, s[16:19], s34 offen offset:2048  lds
    buffer_load_dwordx4 v39, s[16:19], s34 offen offset:3072  lds
    s_bitcmp1_b32 s3, 1
    s_cbranch_scc1 L_t6b
    s_barrier
L_t6b:
    s_add_u32 s37, s34, 128
    s_waitcnt vmcnt(0)
    ds_read_b128 v[48:51], v20
    ds_read_b128 v[52:55], v21
    ds_read_b128 v[56:59], v22
    ds_read_b128 v[60:63], v23
    s_waitcnt lgkmcnt(0)
    buffer_load_dwordx4 v36, s[16:19], s37 offen offset:0  lds
    buffer_load_dwordx4 v37, s[16:19], s37 offen offset:1024  lds
    buffer_load_dwordx4 v38, s[16:19], s37 offen offset:2048  lds
    buffer_load_dwordx4 v39, s[16:19], s37 offen offset:3072  lds
    s_waitcnt vmcnt(0)
    ds_read_b128 v[64:67], v20
    ds_read_b128 v[68:71], v21
    ds_read_b128 v[72:75], v22
    ds_read_b128 v[76:79], v23
L_mainB:
    ds_read_b128 v[208:211], v8 offset:0
    ds_read_b128 v[212:215], v9 offset:0
    ds_read_b128 v[216:219], v10 offset:0
    ds_read_b128 v[220:223], v11 offset:0
    ds_read_b128 v[224:227], v12 offset:0
    ds_read_b128 v[228:231], v13 offset:0
    ds_read_b128 v[232:235], v14 offset:0
    ds_read_b128 v[236:239], v15 offset:0
    s_waitcnt lgkmcnt(7)
    v_mfma_f32_32x32x16_bf16 v[80:95], v[208:211], v[48:51], 0
    ds_read_b128 v[240:243], v8 offset:8192
    ds_read_b128 v[244:247], v9 offset:8192
    s_waitcnt lgkmcnt(8)
    v_mfma_f32_32x32x16_bf16 v[80:95], v[212:215], v[52:55], v[80:95]
    ds_read_b128 v[208:211], v10 offset:8192
    ds_read_b128 v[212:215], v11 offset:8192
    s_waitcnt lgkmcnt(9)
    v_mfma_f32_32x32x16_bf16 v[80:95], v[216:219], v[56:59], v[80:95]
    ds_read_b128 v[216:219], v12 offset:8192
    s_waitcnt lgkmcnt(7)
    v_mfma_f32_32x32x16_bf16 v[80:95], v[220:223], v[60:63], v[80:95]
    ds_read_b128 v[220:223], v13 offset:8192
    v_mfma_f32_32x32x16_bf16 v[80:95], v[224:227], v[64:67], v[80:95]
    ds_read_b128 v[224:227], v14 offset:8192
    v_mfma_f32_32x32x16_bf16 v[80:95], v[228:231], v[68:71], v[80:95]
    ds_read_b128 v[228:231], v15 offset:8192
    s_waitcnt lgkmcnt(7)
    v_mfma_f32_32x32x16_bf16 v[80:95], v[232:235], v[72:75], v[80:95]
    ds_read_b64_tr_b16 v[232:233], v16 offset:0
    ds_read_b64_tr_b16 v[234:235], v16 offset:2048
    v_mfma_f32_32x32x16_bf16 v[80:95], v[236:239], v[76:79], v[80:95]
    ds_read_b64_tr_b16 v[236:237], v17 offset:0
    ds_read_b64_tr_b16 v[238:239], v17 offset:2048
    v_mfma_f32_32x32x16_bf16 v[96:111], v[240:243], v[48:51], 0
    ds_read_b128 v[240:243], v8 offset:16384
    s_waitcnt lgkmcnt(7)
    v_mfma_f32_32x32x16_bf16 v[96:111], v[244:247], v[52:55], v[96:111]
    ds_read_b64_tr_b16 v[244:245], v16 offset:4096
    ds_read_b64_tr_b16 v[246:247], v16 offset:6144
    v_mfma_f32_32x32x16_bf16 v[96:111], v[208:211], v[56:59], v[96:111]
    ds_read_b128 v[208:211], v9 offset:16384
    v_mfma_f32_32x32x16_bf16 v[96:111], v[212:215], v[60:63], v[96:111]
    ds_read_b128 v[212:215], v10 offset:16384
    v_max3_f32 v28, v80, v81, v82
    v_max3_f32 v29, v83, v84, v85
    v_max3_f32 v28, v28, v86, v87
    v_max3_f32 v29, v29, v88, v89
    v_max3_f32 v28, v28, v90, v91
    v_mfma_f32_32x32x16_bf16 v[96:111], v[216:219], v[64:67], v[96:111]
    ds_read_b64_tr_b16 v[216:217], v17 offset:4096
    ds_read_b64_tr_b16 v[218:219], v17 offset:6144
    v_max3_f32 v29, v29, v92, v93
    v_max3_f32 v28, v28, v94, v95
    v_max3_f32 v28, v28, v29, v34
    v_mov_b32 v29, v28
    v_mfma_f32_32x32x16_bf16 v[96:111], v[220:223], v[68:71], v[96:111]
    ds_read_b128 v[220:223], v11 offset:16384
    v_permlane32_swap_b32 v28, v29
    v_max_f32 v28, v28, v29
    v_mul_f32 v30, 0xbe0293ee, v28
    v_fma_f32 v40, v80, v31, v30
    v_fma_f32 v41, v81, v31, v30
    s_waitcnt lgkmcnt(7)
    v_mfma_f32_32x32x16_bf16 v[96:111], v[224:227], v[72:75], v[96:111]
    ds_read_b128 v[224:227], v12 offset:16384
    v_exp_f32 v40, v40
    v_exp_f32 v41, v41
    v_fma_f32 v42, v82, v31, v30
    v_mfma_f32_32x32x16_bf16 v[96:111], v[228:231], v[76:79], v[96:111]
    ds_read_b128 v[228:231], v13 offset:16384
    v_cvt_pk_bf16_f32 v112, v40, v41
    v_fma_f32 v43, v83, v31, v30
    v_exp_f32 v42, v42
    v_exp_f32 v43, v43
    v_fma_f32 v44, v84, v31, v30
    v_cvt_pk_bf16_f32 v113, v42, v43
    v_fma_f32 v45, v85, v31, v30
    v_exp_f32 v44, v44
    v_exp_f32 v45, v45
    v_fma_f32 v46, v86, v31, v30
    v_cvt_pk_bf16_f32 v114, v44, v45
    v_fma_f32 v47, v87, v31, v30
    v_exp_f32 v46, v46
    v_exp_f32 v47, v47
    v_fma_f32 v40, v88, v31, v30
    v_cvt_pk_bf16_f32 v115, v46, v47
    v_fma_f32 v41, v89, v31, v30
    v_exp_f32 v40, v40
    v_mfma_f32_32x32x16_bf16 v[176:191], v[232:235], v[112:115], 0
    ds_read_b128 v[232:235], v14 offset:16384
    v_exp_f32 v41, v41
    v_fma_f32 v42, v90, v31, v30
    v_cvt_pk_bf16_f32 v116, v40, v41
    v_fma_f32 v43, v91, v31, v30
    v_mfma_f32_32x32x16_bf16 v[192:207], v[236:239], v[112:115], 0
    ds_read_b64_tr_b16 v[236:237], v16 offset:8192
    ds_read_b64_tr_b16 v[238:239], v16 offset:10240
    v_exp_f32 v42, v42
    v_exp_f32 v43, v43
    v_mfma_f32_16x16x32_bf16 v[252:255], v[248:251], v[112:115], 0
    v_fma_f32 v44, v92, v31, v30
    v_cvt_pk_bf16_f32 v117, v42, v43
    v_fma_f32 v45, v93, v31, v30
    v_exp_f32 v44, v44
    v_exp_f32 v45, v45
    v_fma_f32 v46, v94, v31, v30
    v_cvt_pk_bf16_f32 v118, v44, v45
    v_fma_f32 v47, v95, v31, v30
    v_mfma_f32_32x32x16_bf16 v[80:95], v[240:243], v[48:51], 0
    ds_read_b128 v[240:243], v15 offset:16384
    v_exp_f32 v46, v46
    v_exp_f32 v47, v47
    s_nop 0
    v_cvt_pk_bf16_f32 v119, v46, v47
    v_fma_f32 v40, v96, v31, v30
    v_fma_f32 v41, v97, v31, v30
    s_waitcnt lgkmcnt(4)
    v_mfma_f32_32x32x16_bf16 v[176:191], v[244:247], v[116:119], v[176:191]
    ds_read_b64_tr_b16 v[244:245], v17 offset:8192
    ds_read_b64_tr_b16 v[246:247], v17 offset:10240
    v_exp_f32 v40, v40
    v_exp_f32 v41, v41
    v_mfma_f32_32x32x16_bf16 v[80:95], v[208:211], v[52:55], v[80:95]
    ds_read_b128 v[208:211], v8 offset:24576
    v_fma_f32 v42, v98, v31, v30
    v_cvt_pk_bf16_f32 v120, v40, v41
    v_fma_f32 v43, v99, v31, v30
    v_exp_f32 v42, v42
    v_mfma_f32_32x32x16_bf16 v[80:95], v[212:215], v[56:59], v[80:95]
    ds_read_b64_tr_b16 v[212:213], v16 offset:12288
    ds_read_b64_tr_b16 v[214:215], v16 offset:14336
    v_exp_f32 v43, v43
    v_fma_f32 v44, v100, v31, v30
    v_cvt_pk_bf16_f32 v121, v42, v43
    v_mfma_f32_32x32x16_bf16 v[192:207], v[216:219], v[116:119], v[192:207]
    ds_read_b128 v[216:219], v9 offset:24576
    v_fma_f32 v45, v101, v31, v30
    v_exp_f32 v44, v44
    v_exp_f32 v45, v45
    v_mfma_f32_16x16x32_bf16 v[252:255], v[248:251], v[116:119], v[252:255]
    v_fma_f32 v46, v102, v31, v30
    v_cvt_pk_bf16_f32 v122, v44, v45
    v_mfma_f32_32x32x16_bf16 v[80:95], v[220:223], v[60:63], v[80:95]
    ds_read_b128 v[220:223], v10 offset:24576
    v_fma_f32 v47, v103, v31, v30
    v_exp_f32 v46, v46
    v_exp_f32 v47, v47
    v_mfma_f32_32x32x16_bf16 v[80:95], v[224:227], v[64:67], v[80:95]
    ds_read_b64_tr_b16 v[224:225], v17 offset:12288
    ds_read_b64_tr_b16 v[226:227], v17 offset:14336
    v_fma_f32 v40, v104, v31, v30
    v_cvt_pk_bf16_f32 v123, v46, v47
    v_fma_f32 v41, v105, v31, v30
    v_mfma_f32_32x32x16_bf16 v[80:95], v[228:231], v[68:71], v[80:95]
    ds_read_b128 v[228:231], v11 offset:24576
    v_exp_f32 v40, v40
    v_exp_f32 v41, v41
    v_fma_f32 v42, v106, v31, v30
    s_waitcnt lgkmcnt(5)
    v_mfma_f32_32x32x16_bf16 v[80:95], v[232:235], v[72:75], v[80:95]
    ds_read_b128 v[232:235], v12 offset:24576
    v_cvt_pk_bf16_f32 v124, v40, v41
    v_fma_f32 v43, v107, v31, v30
    v_exp_f32 v42, v42
    v_mfma_f32_32x32x16_bf16 v[176:191], v[236:239], v[120:123], v[176:191]
    ds_read_b128 v[236:239], v13 offset:24576
    v_exp_f32 v43, v43
    v_fma_f32 v44, v108, v31, v30
    v_cvt_pk_bf16_f32 v125, v42, v43
    v_fma_f32 v45, v109, v31, v30
    v_mfma_f32_32x32x16_bf16 v[80:95], v[240:243], v[76:79], v[80:95]
    ds_read_b128 v[240:243], v14 offset:24576
    v_exp_f32 v44, v44
    v_exp_f32 v45, v45
    v_fma_f32 v46, v110, v31, v30
    v_mfma_f32_32x32x16_bf16 v[192:207], v[244:247], v[120:123], v[192:207]
    ds_read_b64_tr_b16 v[244:245], v16 offset:16384
    ds_read_b64_tr_b16 v[246:247], v16 offset:18432
    v_cvt_pk_bf16_f32 v126, v44, v45
    v_fma_f32 v47, v111, v31, v30
    v_exp_f32 v46, v46
    v_mfma_f32_16x16x32_bf16 v[252:255], v[248:251], v[120:123], v[252:255]
    v_exp_f32 v47, v47
    v_mfma_f32_32x32x16_bf16 v[96:111], v[208:211], v[48:51], 0
    ds_read_b128 v[208:211], v15 offset:24576
    v_cvt_pk_bf16_f32 v127, v46, v47
    v_fma_f32 v40, v80, v31, v30
    v_fma_f32 v41, v81, v31, v30
    v_exp_f32 v40, v40
    v_mfma_f32_32x32x16_bf16 v[176:191], v[212:215], v[124:127], v[176:191]
    ds_read_b64_tr_b16 v[212:213], v17 offset:16384
    ds_read_b64_tr_b16 v[214:215], v17 offset:18432
    v_exp_f32 v41, v41
    v_fma_f32 v42, v82, v31, v30
    v_cvt_pk_bf16_f32 v128, v40, v41
    s_waitcnt lgkmcnt(6)
    v_mfma_f32_32x32x16_bf16 v[96:111], v[216:219], v[52:55], v[96:111]
    ds_read_b128 v[216:219], v8 offset:32768
    v_fma_f32 v43, v83, v31, v30
    v_exp_f32 v42, v42
    v_exp_f32 v43, v43
    v_mfma_f32_32x32x16_bf16 v[96:111], v[220:223], v[56:59], v[96:111]
    ds_read_b64_tr_b16 v[220:221], v16 offset:20480
    ds_read_b64_tr_b16 v[222:223], v16 offset:22528
    v_fma_f32 v44, v84, v31, v30
    v_cvt_pk_bf16_f32 v129, v42, v43
    v_fma_f32 v45, v85, v31, v30
    v_mfma_f32_32x32x16_bf16 v[192:207], v[224:227], v[124:127], v[192:207]
    ds_read_b128 v[224:227], v9 offset:32768
    v_exp_f32 v44, v44
    v_exp_f32 v45, v45
    v_fma_f32 v46, v86, v31, v30
    v_mfma_f32_16x16x32_bf16 v[252:255], v[248:251], v[124:127], v[252:255]
    v_cvt_pk_bf16_f32 v130, v44, v45
    v_fma_f32 v47, v87, v31, v30
    v_mfma_f32_32x32x16_bf16 v[96:111], v[228:231], v[60:63], v[96:111]
    ds_read_b128 v[228:231], v10 offset:32768
    v_exp_f32 v46, v46
    v_exp_f32 v47, v47
    v_fma_f32 v40, v88, v31, v30
    v_mfma_f32_32x32x16_bf16 v[96:111], v[232:235], v[64:67], v[96:111]
    ds_read_b64_tr_b16 v[232:233], v17 offset:20480
    ds_read_b64_tr_b16 v[234:235], v17 offset:22528
    v_cvt_pk_bf16_f32 v131, v46, v47
    v_fma_f32 v41, v89, v31, v30
    v_exp_f32 v40, v40
    v_mfma_f32_32x32x16_bf16 v[96:111], v[236:239], v[68:71], v[96:111]
    ds_read_b128 v[236:239], v11 offset:32768
    v_exp_f32 v41, v41
    v_fma_f32 v42, v90, v31, v30
    v_cvt_pk_bf16_f32 v132, v40, v41
    v_fma_f32 v43, v91, v31, v30
    s_waitcnt lgkmcnt(5)
    v_mfma_f32_32x32x16_bf16 v[96:111], v[240:243], v[72:75], v[96:111]
    ds_read_b128 v[240:243], v12 offset:32768
    v_exp_f32 v42, v42
    v_exp_f32 v43, v43
    v_fma_f32 v44, v92, v31, v30
    v_mfma_f32_32x32x16_bf16 v[176:191], v[244:247], v[128:131], v[176:191]
    ds_read_b128 v[244:247], v13 offset:32768
    v_cvt_pk_bf16_f32 v133, v42, v43
    v_fma_f32 v45, v93, v31, v30
    v_exp_f32 v44, v44
    v_mfma_f32_32x32x16_bf16 v[96:111], v[208:211], v[76:79], v[96:111]
    ds_read_b128 v[208:211], v14 offset:32768
    v_exp_f32 v45, v45
    v_fma_f32 v46, v94, v31, v30
    v_cvt_pk_bf16_f32 v134, v44, v45
    v_fma_f32 v47, v95, v31, v30
    v_mfma_f32_32x32x16_bf16 v[192:207], v[212:215], v[128:131], v[192:207]
    ds_read_b64_tr_b16 v[212:213], v16 offset:24576
    ds_read_b64_tr_b16 v[214:215], v16 offset:26624
    v_exp_f32 v46, v46
    v_exp_f32 v47, v47
    v_mfma_f32_16x16x32_bf16 v[252:255], v[248:251], v[128:131], v[252:255]
    v_cvt_pk_bf16_f32 v135, v46, v47
    v_fma_f32 v40, v96, v31, v30
    v_mfma_f32_32x32x16_bf16 v[80:95], v[216:219], v[48:51], 0
    ds_read_b128 v[216:219], v15 offset:32768
    v_fma_f32 v41, v97, v31, v30
    v_exp_f32 v40, v40
    v_exp_f32 v41, v41
    v_mfma_f32_32x32x16_bf16 v[176:191], v[220:223], v[132:135], v[176:191]
    ds_read_b64_tr_b16 v[220:221], v17 offset:24576
    ds_read_b64_tr_b16 v[222:223], v17 offset:26624
    v_fma_f32 v42, v98, v31, v30
    v_cvt_pk_bf16_f32 v136, v40, v41
    v_fma_f32 v43, v99, v31, v30
    s_waitcnt lgkmcnt(6)
    v_mfma_f32_32x32x16_bf16 v[80:95], v[224:227], v[52:55], v[80:95]
    ds_read_b128 v[224:227], v8 offset:40960
    v_exp_f32 v42, v42
    v_exp_f32 v43, v43
    v_fma_f32 v44, v100, v31, v30
    v_mfma_f32_32x32x16_bf16 v[80:95], v[228:231], v[56:59], v[80:95]
    ds_read_b64_tr_b16 v[228:229], v16 offset:28672
    ds_read_b64_tr_b16 v[230:231], v16 offset:30720
    v_cvt_pk_bf16_f32 v137, v42, v43
    v_fma_f32 v45, v101, v31, v30
    v_exp_f32 v44, v44
    v_mfma_f32_32x32x16_bf16 v[192:207], v[232:235], v[132:135], v[192:207]
    ds_read_b128 v[232:235], v9 offset:40960
    v_exp_f32 v45, v45
    v_fma_f32 v46, v102, v31, v30
    v_cvt_pk_bf16_f32 v138, v44, v45
    v_fma_f32 v47, v103, v31, v30
    v_mfma_f32_16x16x32_bf16 v[252:255], v[248:251], v[132:135], v[252:255]
    v_exp_f32 v46, v46
    v_mfma_f32_32x32x16_bf16 v[80:95], v[236:239], v[60:63], v[80:95]
    ds_read_b128 v[236:239], v10 offset:40960
    v_exp_f32 v47, v47
    v_fma_f32 v40, v104, v31, v30
    v_cvt_pk_bf16_f32 v139, v46, v47
    v_fma_f32 v41, v105, v31, v30
    v_mfma_f32_32x32x16_bf16 v[80:95], v[240:243], v[64:67], v[80:95]
    ds_read_b64_tr_b16 v[240:241], v17 offset:28672
    ds_read_b64_tr_b16 v[242:243], v17 offset:30720
    v_exp_f32 v40, v40
    v_exp_f32 v41, v41
    v_mfma_f32_32x32x16_bf16 v[80:95], v[244:247], v[68:71], v[80:95]
    ds_read_b128 v[244:247], v11 offset:40960
    v_fma_f32 v42, v106, v31, v30
    v_cvt_pk_bf16_f32 v140, v40, v41
    v_fma_f32 v43, v107, v31, v30
    v_exp_f32 v42, v42
    s_waitcnt lgkmcnt(5)
    v_mfma_f32_32x32x16_bf16 v[80:95], v[208:211], v[72:75], v[80:95]
    ds_read_b128 v[208:211], v12 offset:40960
    v_exp_f32 v43, v43
    v_fma_f32 v44, v108, v31, v30
    v_cvt_pk_bf16_f32 v141, v42, v43
    v_fma_f32 v45, v109, v31, v30
    v_mfma_f32_32x32x16_bf16 v[176:191], v[212:215], v[136:139], v[176:191]
    ds_read_b128 v[212:215], v13 offset:40960
    v_exp_f32 v44, v44
    v_exp_f32 v45, v45
    v_fma_f32 v46, v110, v31, v30
    v_mfma_f32_32x32x16_bf16 v[80:95], v[216:219], v[76:79], v[80:95]
    ds_read_b128 v[216:219], v14 offset:40960
    v_cvt_pk_bf16_f32 v142, v44, v45
    v_fma_f32 v47, v111, v31, v30
    v_exp_f32 v46, v46
    v_mfma_f32_32x32x16_bf16 v[192:207], v[220:223], v[136:139], v[192:207]
    ds_read_b64_tr_b16 v[220:221], v16 offset:32768
    ds_read_b64_tr_b16 v[222:223], v16 offset:34816
    v_exp_f32 v47, v47
    v_mfma_f32_16x16x32_bf16 v[252:255], v[248:251], v[136:139], v[252:255]
    v_cvt_pk_bf16_f32 v143, v46, v47
    v_mfma_f32_32x32x16_bf16 v[96:111], v[224:227], v[48:51], 0
    ds_read_b128 v[224:227], v15 offset:40960
    v_fma_f32 v40, v80, v31, v30
    v_fma_f32 v41, v81, v31, v30
    v_exp_f32 v40, v40
    v_mfma_f32_32x32x16_bf16 v[176:191], v[228:231], v[140:143], v[176:191]
    ds_read_b64_tr_b16 v[228:229], v17 offset:32768
    ds_read_b64_tr_b16 v[230:231], v17 offset:34816
    v_exp_f32 v41, v41
    v_fma_f32 v42, v82, v31, v30
    v_cvt_pk_bf16_f32 v144, v40, v41
    s_waitcnt lgkmcnt(6)
    v_mfma_f32_32x32x16_bf16 v[96:111], v[232:235], v[52:55], v[96:111]
    ds_read_b128 v[232:235], v8 offset:49152
    v_fma_f32 v43, v83, v31, v30
    v_exp_f32 v42, v42
    v_exp_f32 v43, v43
    v_mfma_f32_32x32x16_bf16 v[96:111], v[236:239], v[56:59], v[96:111]
    ds_read_b64_tr_b16 v[236:237], v16 offset:36864
    ds_read_b64_tr_b16 v[238:239], v16 offset:38912
    v_fma_f32 v44, v84, v31, v30
    v_cvt_pk_bf16_f32 v145, v42, v43
    v_fma_f32 v45, v85, v31, v30
    v_mfma_f32_32x32x16_bf16 v[192:207], v[240:243], v[140:143], v[192:207]
    ds_read_b128 v[240:243], v9 offset:49152
    v_exp_f32 v44, v44
    v_exp_f32 v45, v45
    v_fma_f32 v46, v86, v31, v30
    v_mfma_f32_16x16x32_bf16 v[252:255], v[248:251], v[140:143], v[252:255]
    v_cvt_pk_bf16_f32 v146, v44, v45
    v_fma_f32 v47, v87, v31, v30
    v_mfma_f32_32x32x16_bf16 v[96:111], v[244:247], v[60:63], v[96:111]
    ds_read_b128 v[244:247], v10 offset:49152
    v_exp_f32 v46, v46
    v_exp_f32 v47, v47
    v_fma_f32 v40, v88, v31, v30
    v_mfma_f32_32x32x16_bf16 v[96:111], v[208:211], v[64:67], v[96:111]
    ds_read_b64_tr_b16 v[208:209], v17 offset:36864
    ds_read_b64_tr_b16 v[210:211], v17 offset:38912
    v_cvt_pk_bf16_f32 v147, v46, v47
    v_fma_f32 v41, v89, v31, v30
    v_exp_f32 v40, v40
    v_mfma_f32_32x32x16_bf16 v[96:111], v[212:215], v[68:71], v[96:111]
    ds_read_b128 v[212:215], v11 offset:49152
    v_exp_f32 v41, v41
    v_fma_f32 v42, v90, v31, v30
    v_cvt_pk_bf16_f32 v148, v40, v41
    v_fma_f32 v43, v91, v31, v30
    s_waitcnt lgkmcnt(5)
    v_mfma_f32_32x32x16_bf16 v[96:111], v[216:219], v[72:75], v[96:111]
    ds_read_b128 v[216:219], v12 offset:49152
    v_exp_f32 v42, v42
    v_exp_f32 v43, v43
    v_fma_f32 v44, v92, v31, v30
    v_mfma_f32_32x32x16_bf16 v[176:191], v[220:223], v[144:147], v[176:191]
    ds_read_b128 v[220:223], v13 offset:49152
    v_cvt_pk_bf16_f32 v149, v42, v43
    v_fma_f32 v45, v93, v31, v30
    v_exp_f32 v44, v44
    v_mfma_f32_32x32x16_bf16 v[96:111], v[224:227], v[76:79], v[96:111]
    ds_read_b128 v[224:227], v14 offset:49152
    v_exp_f32 v45, v45
    v_fma_f32 v46, v94, v31, v30
    v_cvt_pk_bf16_f32 v150, v44, v45
    v_fma_f32 v47, v95, v31, v30
    v_mfma_f32_32x32x16_bf16 v[192:207], v[228:231], v[144:147], v[192:207]
    ds_read_b64_tr_b16 v[228:229], v16 offset:40960
    ds_read_b64_tr_b16 v[230:231], v16 offset:43008
    v_exp_f32 v46, v46
    v_exp_f32 v47, v47
    v_mfma_f32_16x16x32_bf16 v[252:255], v[248:251], v[144:147], v[252:255]
    v_cvt_pk_bf16_f32 v151, v46, v47
    v_fma_f32 v40, v96, v31, v30
    v_mfma_f32_32x32x16_bf16 v[80:95], v[232:235], v[48:51], 0
    ds_read_b128 v[232:235], v15 offset:49152
    v_fma_f32 v41, v97, v31, v30
    v_exp_f32 v40, v40
    v_exp_f32 v41, v41
    v_mfma_f32_32x32x16_bf16 v[176:191], v[236:239], v[148:151], v[176:191]
    ds_read_b64_tr_b16 v[236:237], v17 offset:40960
    ds_read_b64_tr_b16 v[238:239], v17 offset:43008
    v_fma_f32 v42, v98, v31, v30
    v_cvt_pk_bf16_f32 v152, v40, v41
    v_fma_f32 v43, v99, v31, v30
    s_waitcnt lgkmcnt(6)
    v_mfma_f32_32x32x16_bf16 v[80:95], v[240:243], v[52:55], v[80:95]
    ds_read_b128 v[240:243], v8 offset:57344
    v_exp_f32 v42, v42
    v_exp_f32 v43, v43
    v_fma_f32 v44, v100, v31, v30
    v_mfma_f32_32x32x16_bf16 v[80:95], v[244:247], v[56:59], v[80:95]
    ds_read_b64_tr_b16 v[244:245], v16 offset:45056
    ds_read_b64_tr_b16 v[246:247], v16 offset:47104
    v_cvt_pk_bf16_f32 v153, v42, v43
    v_fma_f32 v45, v101, v31, v30
    v_exp_f32 v44, v44
    v_mfma_f32_32x32x16_bf16 v[192:207], v[208:211], v[148:151], v[192:207]
    ds_read_b128 v[208:211], v9 offset:57344
    v_exp_f32 v45, v45
    v_fma_f32 v46, v102, v31, v30
    v_cvt_pk_bf16_f32 v154, v44, v45
    v_fma_f32 v47, v103, v31, v30
    v_mfma_f32_16x16x32_bf16 v[252:255], v[248:251], v[148:151], v[252:255]
    v_exp_f32 v46, v46
    v_mfma_f32_32x32x16_bf16 v[80:95], v[212:215], v[60:63], v[80:95]
    ds_read_b128 v[212:215], v10 offset:57344
    v_exp_f32 v47, v47
    v_fma_f32 v40, v104, v31, v30
    v_cvt_pk_bf16_f32 v155, v46, v47
    v_fma_f32 v41, v105, v31, v30
    v_mfma_f32_32x32x16_bf16 v[80:95], v[216:219], v[64:67], v[80:95]
    ds_read_b64_tr_b16 v[216:217], v17 offset:45056
    ds_read_b64_tr_b16 v[218:219], v17 offset:47104
    v_exp_f32 v40, v40
    v_exp_f32 v41, v41
    v_mfma_f32_32x32x16_bf16 v[80:95], v[220:223], v[68:71], v[80:95]
    ds_read_b128 v[220:223], v11 offset:57344
    v_fma_f32 v42, v106, v31, v30
    v_cvt_pk_bf16_f32 v156, v40, v41
    v_fma_f32 v43, v107, v31, v30
    v_exp_f32 v42, v42
    s_waitcnt lgkmcnt(5)
    v_mfma_f32_32x32x16_bf16 v[80:95], v[224:227], v[72:75], v[80:95]
    ds_read_b128 v[224:227], v12 offset:57344
    v_exp_f32 v43, v43
    v_fma_f32 v44, v108, v31, v30
    v_cvt_pk_bf16_f32 v157, v42, v43
    v_fma_f32 v45, v109, v31, v30
    v_mfma_f32_32x32x16_bf16 v[176:191], v[228:231], v[152:155], v[176:191]
    ds_read_b128 v[228:231], v13 offset:57344
    v_exp_f32 v44, v44
    v_exp_f32 v45, v45
    v_fma_f32 v46, v110, v31, v30
    v_mfma_f32_32x32x16_bf16 v[80:95], v[232:235], v[76:79], v[80:95]
    ds_read_b128 v[232:235], v14 offset:57344
    v_cvt_pk_bf16_f32 v158, v44, v45
    v_fma_f32 v47, v111, v31, v30
    v_exp_f32 v46, v46
    v_mfma_f32_32x32x16_bf16 v[192:207], v[236:239], v[152:155], v[192:207]
    ds_read_b64_tr_b16 v[236:237], v16 offset:49152
    ds_read_b64_tr_b16 v[238:239], v16 offset:51200
    v_exp_f32 v47, v47
    v_mfma_f32_16x16x32_bf16 v[252:255], v[248:251], v[152:155], v[252:255]
    v_cvt_pk_bf16_f32 v159, v46, v47
    v_mfma_f32_32x32x16_bf16 v[96:111], v[240:243], v[48:51], 0
    ds_read_b128 v[240:243], v15 offset:57344
    v_fma_f32 v40, v80, v31, v30
    v_fma_f32 v41, v81, v31, v30
    v_exp_f32 v40, v40
    v_mfma_f32_32x32x16_bf16 v[176:191], v[244:247], v[156:159], v[176:191]
    ds_read_b64_tr_b16 v[244:245], v17 offset:49152
    ds_read_b64_tr_b16 v[246:247], v17 offset:51200
    v_exp_f32 v41, v41
    v_fma_f32 v42, v82, v31, v30
    v_cvt_pk_bf16_f32 v160, v40, v41
    s_waitcnt lgkmcnt(6)
    v_mfma_f32_32x32x16_bf16 v[96:111], v[208:211], v[52:55], v[96:111]
    ds_read_b64_tr_b16 v[208:209], v16 offset:53248
    ds_read_b64_tr_b16 v[210:211], v16 offset:55296
    v_fma_f32 v43, v83, v31, v30
    v_exp_f32 v42, v42
    v_mfma_f32_32x32x16_bf16 v[96:111], v[212:215], v[56:59], v[96:111]
    ds_read_b64_tr_b16 v[212:213], v17 offset:53248
    ds_read_b64_tr_b16 v[214:215], v17 offset:55296
    v_exp_f32 v43, v43
    v_fma_f32 v44, v84, v31, v30
    v_cvt_pk_bf16_f32 v161, v42, v43
    v_mfma_f32_32x32x16_bf16 v[192:207], v[216:219], v[156:159], v[192:207]
    v_fma_f32 v45, v85, v31, v30
    v_exp_f32 v44, v44
    v_exp_f32 v45, v45
    v_fma_f32 v46, v86, v31, v30
    v_mfma_f32_16x16x32_bf16 v[252:255], v[248:251], v[156:159], v[252:255]
    ds_read_b64_tr_b16 v[216:217], v16 offset:57344
    ds_read_b64_tr_b16 v[218:219], v16 offset:59392
    v_mfma_f32_32x32x16_bf16 v[96:111], v[220:223], v[60:63], v[96:111]
    ds_read_b64_tr_b16 v[220:221], v17 offset:57344
    ds_read_b64_tr_b16 v[222:223], v17 offset:59392
    v_cvt_pk_bf16_f32 v162, v44, v45
    v_fma_f32 v47, v87, v31, v30
    v_exp_f32 v46, v46
    v_mfma_f32_32x32x16_bf16 v[96:111], v[224:227], v[64:67], v[96:111]
    v_exp_f32 v47, v47
    v_fma_f32 v40, v88, v31, v30
    v_cvt_pk_bf16_f32 v163, v46, v47
    v_fma_f32 v41, v89, v31, v30
    v_mfma_f32_32x32x16_bf16 v[96:111], v[228:231], v[68:71], v[96:111]
    v_exp_f32 v40, v40
    v_exp_f32 v41, v41
    v_fma_f32 v42, v90, v31, v30
    v_cvt_pk_bf16_f32 v164, v40, v41
    s_waitcnt lgkmcnt(4)
    v_mfma_f32_32x32x16_bf16 v[96:111], v[232:235], v[72:75], v[96:111]
    ds_read_b64_tr_b16 v[224:225], v16 offset:61440
    ds_read_b64_tr_b16 v[226:227], v16 offset:63488
    v_fma_f32 v43, v91, v31, v30
    v_exp_f32 v42, v42
    v_mfma_f32_32x32x16_bf16 v[176:191], v[236:239], v[160:163], v[176:191]
    ds_read_b64_tr_b16 v[228:229], v17 offset:61440
    ds_read_b64_tr_b16 v[230:231], v17 offset:63488
    v_exp_f32 v43, v43
    v_fma_f32 v44, v92, v31, v30
    v_cvt_pk_bf16_f32 v165, v42, v43
    v_mfma_f32_32x32x16_bf16 v[96:111], v[240:243], v[76:79], v[96:111]
    ds_read_b64_tr_b16 v[232:233], v18 offset:0
    ds_read_b64_tr_b16 v[234:235], v18 offset:2048
    v_fma_f32 v45, v93, v31, v30
    v_exp_f32 v44, v44
    v_mfma_f32_32x32x16_bf16 v[192:207], v[244:247], v[160:163], v[192:207]
    ds_read_b64_tr_b16 v[236:237], v18 offset:4096
    ds_read_b64_tr_b16 v[238:239], v18 offset:6144
    v_exp_f32 v45, v45
    v_fma_f32 v46, v94, v31, v30
    v_cvt_pk_bf16_f32 v166, v44, v45
    v_mfma_f32_16x16x32_bf16 v[252:255], v[248:251], v[160:163], v[252:255]
    ds_read_b64_tr_b16 v[240:241], v18 offset:8192
    ds_read_b64_tr_b16 v[242:243], v18 offset:10240
    v_fma_f32 v47, v95, v31, v30
    v_exp_f32 v46, v46
    v_exp_f32 v47, v47
    s_nop 0
    v_cvt_pk_bf16_f32 v167, v46, v47
    v_fma_f32 v40, v96, v31, v30
    v_fma_f32 v41, v97, v31, v30
    v_mfma_f32_32x32x16_bf16 v[176:191], v[208:211], v[164:167], v[176:191]
    ds_read_b64_tr_b16 v[244:245], v18 offset:12288
    ds_read_b64_tr_b16 v[246:247], v18 offset:14336
    v_exp_f32 v40, v40
    v_exp_f32 v41, v41
    v_mfma_f32_32x32x16_bf16 v[192:207], v[212:215], v[164:167], v[192:207]
    ds_read_b64_tr_b16 v[208:209], v18 offset:16384
    ds_read_b64_tr_b16 v[210:211], v18 offset:18432
    v_fma_f32 v42, v98, v31, v30
    v_cvt_pk_bf16_f32 v168, v40, v41
    v_fma_f32 v43, v99, v31, v30
    v_mfma_f32_16x16x32_bf16 v[252:255], v[248:251], v[164:167], v[252:255]
    ds_read_b64_tr_b16 v[212:213], v18 offset:20480
    ds_read_b64_tr_b16 v[214:215], v18 offset:22528
    v_exp_f32 v42, v42
    v_exp_f32 v43, v43
    v_fma_f32 v44, v100, v31, v30
    v_cvt_pk_bf16_f32 v169, v42, v43
    v_fma_f32 v45, v101, v31, v30
    v_exp_f32 v44, v44
    v_exp_f32 v45, v45
    v_fma_f32 v46, v102, v31, v30
    v_cvt_pk_bf16_f32 v170, v44, v45
    v_fma_f32 v47, v103, v31, v30
    v_exp_f32 v46, v46
    v_exp_f32 v47, v47
    v_fma_f32 v40, v104, v31, v30
    v_cvt_pk_bf16_f32 v171, v46, v47
    v_fma_f32 v41, v105, v31, v30
    v_exp_f32 v40, v40
    s_waitcnt lgkmcnt(5)
    v_mfma_f32_32x32x16_bf16 v[176:191], v[216:219], v[168:171], v[176:191]
    ds_read_b64_tr_b16 v[216:217], v18 offset:24576
    ds_read_b64_tr_b16 v[218:219], v18 offset:26624
    v_exp_f32 v41, v41
    v_fma_f32 v42, v106, v31, v30
    v_cvt_pk_bf16_f32 v172, v40, v41
    v_mfma_f32_32x32x16_bf16 v[192:207], v[220:223], v[168:171], v[192:207]
    ds_read_b64_tr_b16 v[220:221], v18 offset:28672
    ds_read_b64_tr_b16 v[222:223], v18 offset:30720
    v_fma_f32 v43, v107, v31, v30
    v_exp_f32 v42, v42
    v_mfma_f32_16x16x32_bf16 v[252:255], v[248:251], v[168:171], v[252:255]
    v_exp_f32 v43, v43
    v_fma_f32 v44, v108, v31, v30
    v_cvt_pk_bf16_f32 v173, v42, v43
    v_fma_f32 v45, v109, v31, v30
    v_exp_f32 v44, v44
    v_exp_f32 v45, v45
    v_fma_f32 v46, v110, v31, v30
    v_cvt_pk_bf16_f32 v174, v44, v45
    v_fma_f32 v47, v111, v31, v30
    v_exp_f32 v46, v46
    v_exp_f32 v47, v47
    s_nop 0
    v_cvt_pk_bf16_f32 v175, v46, v47
    s_nop 1
    v_mfma_f32_16x16x32_bf16 v[252:255], v[248:251], v[172:175], v[252:255]
    v_mfma_f32_32x32x16_bf16 v[176:191], v[224:227], v[172:175], v[176:191]
    ds_read_b64_tr_b16 v[224:225], v18 offset:32768
    ds_read_b64_tr_b16 v[226:227], v18 offset:34816
    v_mfma_f32_32x32x16_bf16 v[192:207], v[228:231], v[172:175], v[192:207]
    ds_read_b64_tr_b16 v[228:229], v18 offset:36864
    ds_read_b64_tr_b16 v[230:231], v18 offset:38912
    v_mfma_f32_32x32x16_bf16 v[48:63], v[232:235], v[112:115], 0
    ds_read_b64_tr_b16 v[232:233], v18 offset:40960
    ds_read_b64_tr_b16 v[234:235], v18 offset:43008
    v_cmp_nge_f32 vcc, v6, v252
    v_rcp_f32 v35, v252
    v_xor_b32 v21, 32, v24
    v_mfma_f32_32x32x16_bf16 v[48:63], v[236:239], v[116:119], v[48:63]
    ds_read_b64_tr_b16 v[236:237], v18 offset:45056
    ds_read_b64_tr_b16 v[238:239], v18 offset:47104
    v_xor_b32 v22, 64, v24
    v_xor_b32 v23, 96, v24
    s_and_b64 vcc, vcc, s[96:97]
    s_cbranch_vccnz L_fb
    v_mfma_f32_32x32x16_bf16 v[48:63], v[240:243], v[120:123], v[48:63]
    ds_read_b64_tr_b16 v[240:241], v18 offset:49152
    ds_read_b64_tr_b16 v[242:243], v18 offset:51200
    v_mul_f32 v176, v35, v176
    v_mul_f32 v177, v35, v177
    v_mul_f32 v178, v35, v178
    v_mul_f32 v179, v35, v179
    s_waitcnt lgkmcnt(10)
    v_mfma_f32_32x32x16_bf16 v[48:63], v[244:247], v[124:127], v[48:63]
    ds_read_b64_tr_b16 v[244:245], v18 offset:53248
    ds_read_b64_tr_b16 v[246:247], v18 offset:55296
    v_mul_f32 v180, v35, v180
    v_mul_f32 v181, v35, v181
    v_mul_f32 v182, v35, v182
    v_mul_f32 v183, v35, v183
    v_mfma_f32_32x32x16_bf16 v[48:63], v[208:211], v[128:131], v[48:63]
    ds_read_b64_tr_b16 v[208:209], v18 offset:57344
    ds_read_b64_tr_b16 v[210:211], v18 offset:59392
    v_cvt_pk_bf16_f32 v176, v176, v177
    v_cvt_pk_bf16_f32 v177, v178, v179
    v_cvt_pk_bf16_f32 v178, v180, v181
    v_cvt_pk_bf16_f32 v179, v182, v183
    v_mfma_f32_32x32x16_bf16 v[48:63], v[212:215], v[132:135], v[48:63]
    ds_read_b64_tr_b16 v[212:213], v18 offset:61440
    ds_read_b64_tr_b16 v[214:215], v18 offset:63488
    ds_write_b128 v24, v[176:179]
    v_mul_f32 v184, v35, v184
    v_mul_f32 v185, v35, v185
    v_mul_f32 v186, v35, v186
    v_mfma_f32_32x32x16_bf16 v[48:63], v[216:219], v[136:139], v[48:63]
    v_mul_f32 v187, v35, v187
    v_mul_f32 v188, v35, v188
    v_mul_f32 v189, v35, v189
    v_mul_f32 v190, v35, v190
    v_mul_f32 v191, v35, v191
    v_cvt_pk_bf16_f32 v180, v184, v185
    v_mfma_f32_32x32x16_bf16 v[48:63], v[220:223], v[140:143], v[48:63]
    ds_read_b64_tr_b16 v[216:217], v19 offset:0
    ds_read_b64_tr_b16 v[218:219], v19 offset:2048
    v_cvt_pk_bf16_f32 v181, v186, v187
    v_cvt_pk_bf16_f32 v182, v188, v189
    v_cvt_pk_bf16_f32 v183, v190, v191
    v_mul_f32 v192, v35, v192
    s_waitcnt lgkmcnt(9)
    v_mfma_f32_32x32x16_bf16 v[48:63], v[224:227], v[144:147], v[48:63]
    ds_read_b64_tr_b16 v[220:221], v19 offset:4096
    ds_read_b64_tr_b16 v[222:223], v19 offset:6144
    ds_write_b128 v21, v[180:183]
    v_mul_f32 v193, v35, v193
    v_mul_f32 v194, v35, v194
    v_mul_f32 v195, v35, v195
    v_mfma_f32_32x32x16_bf16 v[48:63], v[228:231], v[148:151], v[48:63]
    v_mul_f32 v196, v35, v196
    v_mul_f32 v197, v35, v197
    v_mul_f32 v198, v35, v198
    v_mul_f32 v199, v35, v199
    v_cvt_pk_bf16_f32 v192, v192, v193
    v_cvt_pk_bf16_f32 v193, v194, v195
    v_mfma_f32_32x32x16_bf16 v[48:63], v[232:235], v[152:155], v[48:63]
    ds_read_b64_tr_b16 v[224:225], v19 offset:8192
    ds_read_b64_tr_b16 v[226:227], v19 offset:10240
    v_cvt_pk_bf16_f32 v194, v196, v197
    v_cvt_pk_bf16_f32 v195, v198, v199
    v_mul_f32 v200, v35, v200
    v_mul_f32 v201, v35, v201
    v_mfma_f32_32x32x16_bf16 v[48:63], v[236:239], v[156:159], v[48:63]
    ds_read_b64_tr_b16 v[228:229], v19 offset:12288
    ds_read_b64_tr_b16 v[230:231], v19 offset:14336
    ds_write_b128 v22, v[192:195]
    v_mul_f32 v202, v35, v202
    v_mul_f32 v203, v35, v203
    v_mul_f32 v204, v35, v204
    v_mfma_f32_32x32x16_bf16 v[48:63], v[240:243], v[160:163], v[48:63]
    v_mul_f32 v205, v35, v205
    v_mul_f32 v206, v35, v206
    v_mul_f32 v207, v35, v207
    v_cvt_pk_bf16_f32 v196, v200, v201
    v_cvt_pk_bf16_f32 v197, v202, v203
    v_cvt_pk_bf16_f32 v198, v204, v205
    s_waitcnt lgkmcnt(8)
    v_mfma_f32_32x32x16_bf16 v[48:63], v[244:247], v[164:167], v[48:63]
    ds_read_b64_tr_b16 v[232:233], v19 offset:16384
    ds_read_b64_tr_b16 v[234:235], v19 offset:18432
    ds_read_b64_tr_b16 v[236:237], v19 offset:20480
    ds_read_b64_tr_b16 v[238:239], v19 offset:22528
    v_cvt_pk_bf16_f32 v199, v206, v207
    v_mfma_f32_32x32x16_bf16 v[48:63], v[208:211], v[168:171], v[48:63]
    ds_read_b64_tr_b16 v[240:241], v19 offset:24576
    ds_read_b64_tr_b16 v[242:243], v19 offset:26624
    ds_write_b128 v23, v[196:199]
    v_mfma_f32_32x32x16_bf16 v[48:63], v[212:215], v[172:175], v[48:63]
    v_mfma_f32_32x32x16_bf16 v[64:79], v[216:219], v[112:115], 0
    ds_read_b64_tr_b16 v[244:245], v19 offset:28672
    ds_read_b64_tr_b16 v[246:247], v19 offset:30720
    ds_read_b64_tr_b16 v[208:209], v19 offset:32768
    ds_read_b64_tr_b16 v[210:211], v19 offset:34816
    s_waitcnt lgkmcnt(11)
    v_mfma_f32_32x32x16_bf16 v[64:79], v[220:223], v[116:119], v[64:79]
    ds_read_b64_tr_b16 v[212:213], v19 offset:36864
    ds_read_b64_tr_b16 v[214:215], v19 offset:38912
    v_mfma_f32_32x32x16_bf16 v[64:79], v[224:227], v[120:123], v[64:79]
    ds_read_b64_tr_b16 v[216:217], v19 offset:40960
    ds_read_b64_tr_b16 v[218:219], v19 offset:43008
    s_waitcnt lgkmcnt(8)
    ds_read_b128 v[80:83], v26 offset:0
    ds_read_b128 v[84:87], v26 offset:1024
    ds_read_b128 v[88:91], v26 offset:2048
    v_mfma_f32_32x32x16_bf16 v[64:79], v[228:231], v[124:127], v[64:79]
    ds_read_b64_tr_b16 v[220:221], v19 offset:45056
    ds_read_b64_tr_b16 v[222:223], v19 offset:47104
    ds_read_b128 v[92:95], v26 offset:3072
    v_mul_f32 v48, v35, v48
    v_mul_f32 v49, v35, v49
    v_mul_f32 v50, v35, v50
    v_mfma_f32_32x32x16_bf16 v[64:79], v[232:235], v[128:131], v[64:79]
    ds_read_b64_tr_b16 v[224:225], v19 offset:49152
    ds_read_b64_tr_b16 v[226:227], v19 offset:51200
    v_mul_f32 v51, v35, v51
    v_mul_f32 v52, v35, v52
    v_mul_f32 v53, v35, v53
    v_mul_f32 v54, v35, v54
    v_mfma_f32_32x32x16_bf16 v[64:79], v[236:239], v[132:135], v[64:79]
    ds_read_b64_tr_b16 v[228:229], v19 offset:53248
    ds_read_b64_tr_b16 v[230:231], v19 offset:55296
    v_mul_f32 v55, v35, v55
    v_cvt_pk_bf16_f32 v48, v48, v49
    v_cvt_pk_bf16_f32 v49, v50, v51
    v_cvt_pk_bf16_f32 v50, v52, v53
    v_mfma_f32_32x32x16_bf16 v[64:79], v[240:243], v[136:139], v[64:79]
    ds_read_b64_tr_b16 v[232:233], v19 offset:57344
    ds_read_b64_tr_b16 v[234:235], v19 offset:59392
    s_waitcnt lgkmcnt(11)
    buffer_store_dwordx4 v[80:83], v27, s[28:31], s92 offen offset:0 sc1
    s_waitcnt lgkmcnt(10)
    buffer_store_dwordx4 v[84:87], v27, s[28:31], s93 offen offset:0 sc1
    v_mfma_f32_32x32x16_bf16 v[64:79], v[244:247], v[140:143], v[64:79]
    ds_read_b64_tr_b16 v[236:237], v19 offset:61440
    ds_read_b64_tr_b16 v[238:239], v19 offset:63488
    s_waitcnt lgkmcnt(11)
    buffer_store_dwordx4 v[88:91], v27, s[28:31], s94 offen offset:0 sc1
    s_waitcnt lgkmcnt(8)
    buffer_store_dwordx4 v[92:95], v27, s[28:31], s95 offen offset:0 sc1
    v_mfma_f32_32x32x16_bf16 v[64:79], v[208:211], v[144:147], v[64:79]
    v_cvt_pk_bf16_f32 v51, v54, v55
    v_mul_f32 v56, v35, v56
    v_mul_f32 v57, v35, v57
    v_mul_f32 v58, v35, v58
    v_mul_f32 v59, v35, v59
    v_mul_f32 v60, v35, v60
    v_mfma_f32_32x32x16_bf16 v[64:79], v[212:215], v[148:151], v[64:79]
    ds_write_b128 v24, v[48:51]
    v_mul_f32 v61, v35, v61
    v_mul_f32 v62, v35, v62
    v_mul_f32 v63, v35, v63
    v_cvt_pk_bf16_f32 v52, v56, v57
    v_cvt_pk_bf16_f32 v53, v58, v59
    v_mfma_f32_32x32x16_bf16 v[64:79], v[216:219], v[152:155], v[64:79]
    v_cvt_pk_bf16_f32 v54, v60, v61
    v_cvt_pk_bf16_f32 v55, v62, v63
    v_mov_b32 v34, v35
    v_mfma_f32_32x32x16_bf16 v[64:79], v[220:223], v[156:159], v[64:79]
    ds_write_b128 v21, v[52:55]
    s_waitcnt lgkmcnt(5)
    v_mfma_f32_32x32x16_bf16 v[64:79], v[224:227], v[160:163], v[64:79]
    v_mfma_f32_32x32x16_bf16 v[64:79], v[228:231], v[164:167], v[64:79]
    s_waitcnt lgkmcnt(2)
    v_mfma_f32_32x32x16_bf16 v[64:79], v[232:235], v[168:171], v[64:79]
    v_mfma_f32_32x32x16_bf16 v[64:79], v[236:239], v[172:175], v[64:79]
    s_nop 11
    v_pk_mul_f32 v[64:65], v[34:35], v[64:65]
    v_pk_mul_f32 v[66:67], v[34:35], v[66:67]
    v_pk_mul_f32 v[68:69], v[34:35], v[68:69]
    v_pk_mul_f32 v[70:71], v[34:35], v[70:71]
    v_cvt_pk_bf16_f32 v64, v64, v65
    v_cvt_pk_bf16_f32 v65, v66, v67
    v_cvt_pk_bf16_f32 v66, v68, v69
    v_cvt_pk_bf16_f32 v67, v70, v71
    ds_write_b128 v22, v[64:67]
    v_pk_mul_f32 v[72:73], v[34:35], v[72:73]
    v_pk_mul_f32 v[74:75], v[34:35], v[74:75]
    v_pk_mul_f32 v[76:77], v[34:35], v[76:77]
    v_pk_mul_f32 v[78:79], v[34:35], v[78:79]
    v_cvt_pk_bf16_f32 v68, v72, v73
    v_cvt_pk_bf16_f32 v69, v74, v75
    v_cvt_pk_bf16_f32 v70, v76, v77
    v_cvt_pk_bf16_f32 v71, v78, v79
    ds_write_b128 v23, v[68:71]
    s_waitcnt lgkmcnt(0)
    ds_read_b128 v[96:99], v26 offset:0
    ds_read_b128 v[100:103], v26 offset:1024
    ds_read_b128 v[104:107], v26 offset:2048
    ds_read_b128 v[108:111], v26 offset:3072
    s_waitcnt lgkmcnt(3)
    buffer_store_dwordx4 v[96:99], v27, s[28:31], s92 offen offset:128 sc1
    s_waitcnt lgkmcnt(2)
    buffer_store_dwordx4 v[100:103], v27, s[28:31], s93 offen offset:128 sc1
    s_waitcnt lgkmcnt(1)
    buffer_store_dwordx4 v[104:107], v27, s[28:31], s94 offen offset:128 sc1
    s_waitcnt lgkmcnt(0)
    buffer_store_dwordx4 v[108:111], v27, s[28:31], s95 offen offset:128 sc1
    s_endpgm
L_A:
    s_add_u32 s28, s10, s15
    s_addc_u32 s29, s11, 0
    s_mov_b32 s30, 0x10000
    s_mov_b32 s31, 0x20000
    v_and_b32 v2, 31, v0
    v_lshrrev_b32 v3, 5, v0
    v_and_b32 v4, 15, v0
    v_xor_b32 v4, v4, v3
    v_lshlrev_b32 v4, 4, v4
    v_lshl_add_u32 v8, v2, 8, v4
    v_xor_b32 v9, 32, v8
    v_xor_b32 v10, 64, v8
    v_xor_b32 v11, 96, v8
    v_xor_b32 v12, 128, v8
    v_xor_b32 v13, 160, v8
    v_xor_b32 v14, 192, v8
    v_xor_b32 v15, 224, v8
    v_bfe_u32 v4, v0, 1, 3
    v_xor_b32 v4, v4, v3
    v_lshlrev_b32 v4, 4, v4
    v_lshl_add_u32 v4, v2, 7, v4
    v_add_u32 v20, s35, v4
    v_xor_b32 v21, 32, v20
    v_xor_b32 v22, 64, v20
    v_xor_b32 v23, 96, v20
    v_bfe_u32 v4, v0, 2, 2
    v_lshl_add_u32 v5, v3, 2, v4
    v_lshlrev_b32 v5, 8, v5
    v_lshl_add_u32 v5, v4, 6, v5
    v_bfe_u32 v6, v0, 4, 1
    v_lshl_add_u32 v5, v6, 5, v5
    v_and_b32 v6, 1, v0
    v_lshl_add_u32 v5, v6, 4, v5
    v_bfe_u32 v6, v0, 1, 1
    v_lshl_add_u32 v5, v6, 3, v5
    v_add_u32 v16, 0x10000, v5
    v_xor_b32 v17, 64, v16
    v_xor_b32 v18, 128, v16
    v_xor_b32 v19, 192, v16
    v_and_b32 v4, 7, v0
    v_xor_b32 v4, v4, v3
    v_lshlrev_b32 v4, 4, v4
    v_lshl_add_u32 v4, v2, 7, v4
    v_add_u32 v24, s35, v4
    v_lshrrev_b32 v4, 3, v0
    v_and_b32 v5, 7, v0
    v_xor_b32 v6, v4, v5
    v_lshlrev_b32 v6, 4, v6
    v_lshl_add_u32 v6, v4, 7, v6
    v_add_u32 v26, s35, v6
    v_lshlrev_b32 v5, 4, v5
    v_lshl_add_u32 v5, v4, 8, v5
    v_add_u32 v27, s34, v5
    s_mov_b32 s92, 0
    s_mov_b32 s93, 2048
    s_mov_b32 s94, 4096
    s_mov_b32 s95, 6144
    v_mov_b32 v31, 0x3e0293ee
    v_mov_b32 v34, 0xff800000
    v_mov_b32 v6, 0x4e800000
    s_setprio 1
    s_barrier
    s_bitcmp1_b32 s3, 1
    s_cbranch_scc0 L_lead
    s_barrier
    s_barrier
L_lead:
    s_waitcnt vmcnt(0)
    ds_read_b128 v[48:51], v20 offset:0
    ds_read_b128 v[208:211], v8 offset:0
    ds_read_b128 v[52:55], v21 offset:0
    ds_read_b128 v[212:215], v9 offset:0
    ds_read_b128 v[56:59], v22 offset:0
    ds_read_b128 v[216:219], v10 offset:0
    ds_read_b128 v[60:63], v23 offset:0
    ds_read_b128 v[220:223], v11 offset:0
    ds_read_b128 v[64:67], v20 offset:4096
    ds_read_b128 v[224:227], v12 offset:0
    ds_read_b128 v[68:71], v21 offset:4096
    ds_read_b128 v[228:231], v13 offset:0
    ds_read_b128 v[72:75], v22 offset:4096
    ds_read_b128 v[232:235], v14 offset:0
    ds_read_b128 v[76:79], v23 offset:4096
    ds_read_b128 v[236:239], v15 offset:0
    s_waitcnt lgkmcnt(14)
    v_mfma_f32_32x32x16_bf16 v[80:95], v[208:211], v[48:51], 0
    s_waitcnt lgkmcnt(12)
    v_mfma_f32_32x32x16_bf16 v[80:95], v[212:215], v[52:55], v[80:95]
    s_waitcnt lgkmcnt(10)
    v_mfma_f32_32x32x16_bf16 v[80:95], v[216:219], v[56:59], v[80:95]
    s_waitcnt lgkmcnt(8)
    v_mfma_f32_32x32x16_bf16 v[80:95], v[220:223], v[60:63], v[80:95]
    s_waitcnt lgkmcnt(1)
    s_cbranch_scc1 L_nb2
    s_barrier
L_nb2:
    ds_read_b128 v[240:243], v8 offset:8192
    ds_read_b128 v[244:247], v9 offset:8192
    ds_read_b128 v[248:251], v10 offset:8192
    ds_read_b128 v[252:255], v11 offset:8192
    v_mfma_f32_32x32x16_bf16 v[80:95], v[224:227], v[64:67], v[80:95]
    ds_read_b128 v[208:211], v12 offset:8192
    ds_read_b128 v[212:215], v13 offset:8192
    v_mfma_f32_32x32x16_bf16 v[80:95], v[228:231], v[68:71], v[80:95]
    ds_read_b128 v[216:219], v14 offset:8192
    ds_read_b128 v[220:223], v15 offset:8192
    v_mfma_f32_32x32x16_bf16 v[80:95], v[232:235], v[72:75], v[80:95]
    s_waitcnt lgkmcnt(8)
    v_mfma_f32_32x32x16_bf16 v[80:95], v[236:239], v[76:79], v[80:95]
    s_waitcnt lgkmcnt(7)
    v_mfma_f32_32x32x16_bf16 v[96:111], v[240:243], v[48:51], 0
    s_cbranch_scc0 L_lg0
    s_barrier
L_lg0:
    s_waitcnt lgkmcnt(6)
    v_mfma_f32_32x32x16_bf16 v[96:111], v[244:247], v[52:55], v[96:111]
    s_waitcnt lgkmcnt(4)
    v_mfma_f32_32x32x16_bf16 v[96:111], v[248:251], v[56:59], v[96:111]
    v_mfma_f32_32x32x16_bf16 v[96:111], v[252:255], v[60:63], v[96:111]
    s_waitcnt lgkmcnt(0)
    v_mfma_f32_32x32x16_bf16 v[96:111], v[208:211], v[64:67], v[96:111]
    v_mfma_f32_32x32x16_bf16 v[96:111], v[212:215], v[68:71], v[96:111]
    v_mfma_f32_32x32x16_bf16 v[96:111], v[216:219], v[72:75], v[96:111]
    v_max3_f32 v28, v80, v81, v82
    v_max3_f32 v29, v83, v84, v85
    v_max3_f32 v28, v28, v86, v87
    v_max3_f32 v29, v29, v88, v89
    v_max3_f32 v28, v28, v90, v91
    v_max3_f32 v29, v29, v92, v93
    v_mfma_f32_32x32x16_bf16 v[96:111], v[220:223], v[76:79], v[96:111]
    v_max3_f32 v28, v28, v94, v95
    v_max3_f32 v28, v28, v29, v34
    v_mov_b32 v29, v28
    s_nop 1
    v_permlane32_swap_b32 v28, v29
    v_max_f32 v28, v28, v29
    v_mul_f32 v30, 0xbe0293ee, v28
    v_fma_f32 v40, v80, v31, v30
    v_fma_f32 v41, v81, v31, v30
    v_exp_f32 v40, v40
    v_exp_f32 v41, v41
    v_mov_b32 v32, v40
    v_mov_b32 v33, v41
    v_cvt_pk_bf16_f32 v112, v40, v41
    v_fma_f32 v42, v82, v31, v30
    v_fma_f32 v43, v83, v31, v30
    v_exp_f32 v42, v42
    v_exp_f32 v43, v43
    v_add_f32 v32, v32, v42
    v_add_f32 v33, v33, v43
    v_cvt_pk_bf16_f32 v113, v42, v43
    v_fma_f32 v44, v84, v31, v30
    v_fma_f32 v45, v85, v31, v30
    v_exp_f32 v44, v44
    v_exp_f32 v45, v45
    v_add_f32 v32, v32, v44
    v_add_f32 v33, v33, v45
    v_cvt_pk_bf16_f32 v114, v44, v45
    s_cbranch_scc1 L_nb4
    s_barrier
L_nb4:
    ds_read_b128 v[224:227], v8 offset:16384
    ds_read_b128 v[228:231], v9 offset:16384
    ds_read_b128 v[232:235], v10 offset:16384
    ds_read_b128 v[236:239], v11 offset:16384
    v_fma_f32 v46, v86, v31, v30
    v_fma_f32 v47, v87, v31, v30
    v_exp_f32 v46, v46
    v_exp_f32 v47, v47
    v_add_f32 v32, v32, v46
    v_add_f32 v33, v33, v47
    v_cvt_pk_bf16_f32 v115, v46, v47
    v_fma_f32 v40, v88, v31, v30
    v_fma_f32 v41, v89, v31, v30
    v_exp_f32 v40, v40
    v_exp_f32 v41, v41
    v_add_f32 v32, v32, v40
    v_add_f32 v33, v33, v41
    v_cvt_pk_bf16_f32 v116, v40, v41
    v_fma_f32 v42, v90, v31, v30
    v_fma_f32 v43, v91, v31, v30
    v_exp_f32 v42, v42
    v_exp_f32 v43, v43
    v_add_f32 v32, v32, v42
    v_add_f32 v33, v33, v43
    v_cvt_pk_bf16_f32 v117, v42, v43
    v_fma_f32 v44, v92, v31, v30
    v_fma_f32 v45, v93, v31, v30
    v_exp_f32 v44, v44
    v_exp_f32 v45, v45
    v_add_f32 v32, v32, v44
    v_add_f32 v33, v33, v45
    v_cvt_pk_bf16_f32 v118, v44, v45
    v_fma_f32 v46, v94, v31, v30
    v_fma_f32 v47, v95, v31, v30
    s_waitcnt lgkmcnt(2)
    v_mfma_f32_32x32x16_bf16 v[80:95], v[224:227], v[48:51], 0
    ds_read_b128 v[240:243], v12 offset:16384
    ds_read_b128 v[244:247], v13 offset:16384
    ds_read_b128 v[248:251], v14 offset:16384
    ds_read_b128 v[252:255], v15 offset:16384
    v_exp_f32 v46, v46
    v_mfma_f32_32x32x16_bf16 v[80:95], v[228:231], v[52:55], v[80:95]
    ds_read_b128 v[208:211], v8 offset:24576
    ds_read_b128 v[212:215], v9 offset:24576
    v_exp_f32 v47, v47
    v_add_f32 v32, v32, v46
    v_add_f32 v33, v33, v47
    s_waitcnt lgkmcnt(6)
    v_mfma_f32_32x32x16_bf16 v[80:95], v[232:235], v[56:59], v[80:95]
    ds_read_b128 v[216:219], v10 offset:24576
    ds_read_b128 v[220:223], v11 offset:24576
    v_cvt_pk_bf16_f32 v119, v46, v47
    v_fma_f32 v40, v96, v31, v30
    v_fma_f32 v41, v97, v31, v30
    v_mfma_f32_32x32x16_bf16 v[80:95], v[236:239], v[60:63], v[80:95]
    ds_read_b128 v[224:227], v12 offset:24576
    ds_read_b128 v[228:231], v13 offset:24576
    v_exp_f32 v40, v40
    v_exp_f32 v41, v41
    s_waitcnt lgkmcnt(9)
    v_mfma_f32_32x32x16_bf16 v[80:95], v[240:243], v[64:67], v[80:95]
    ds_read_b128 v[232:235], v14 offset:24576
    ds_read_b128 v[236:239], v15 offset:24576
    v_add_f32 v32, v32, v40
    v_add_f32 v33, v33, v41
    v_cvt_pk_bf16_f32 v120, v40, v41
    v_fma_f32 v42, v98, v31, v30
    s_waitcnt lgkmcnt(10)
    v_mfma_f32_32x32x16_bf16 v[80:95], v[244:247], v[68:71], v[80:95]
    v_fma_f32 v43, v99, v31, v30
    v_exp_f32 v42, v42
    v_exp_f32 v43, v43
    v_add_f32 v32, v32, v42
    s_waitcnt lgkmcnt(7)
    v_mfma_f32_32x32x16_bf16 v[80:95], v[248:251], v[72:75], v[80:95]
    v_add_f32 v33, v33, v43
    v_cvt_pk_bf16_f32 v121, v42, v43
    v_fma_f32 v44, v100, v31, v30
    v_fma_f32 v45, v101, v31, v30
    v_exp_f32 v44, v44
    v_mfma_f32_32x32x16_bf16 v[80:95], v[252:255], v[76:79], v[80:95]
    v_exp_f32 v45, v45
    v_add_f32 v32, v32, v44
    v_add_f32 v33, v33, v45
    v_cvt_pk_bf16_f32 v122, v44, v45
    v_fma_f32 v46, v102, v31, v30
    v_fma_f32 v47, v103, v31, v30
    v_exp_f32 v46, v46
    v_exp_f32 v47, v47
    v_add_f32 v32, v32, v46
    v_add_f32 v33, v33, v47
    v_cvt_pk_bf16_f32 v123, v46, v47
    v_fma_f32 v40, v104, v31, v30
    v_fma_f32 v41, v105, v31, v30
    v_exp_f32 v40, v40
    v_exp_f32 v41, v41
    v_add_f32 v32, v32, v40
    v_add_f32 v33, v33, v41
    v_cvt_pk_bf16_f32 v124, v40, v41
    v_fma_f32 v42, v106, v31, v30
    v_fma_f32 v43, v107, v31, v30
    v_exp_f32 v42, v42
    v_exp_f32 v43, v43
    v_add_f32 v32, v32, v42
    v_add_f32 v33, v33, v43
    v_cvt_pk_bf16_f32 v125, v42, v43
    v_fma_f32 v44, v108, v31, v30
    v_fma_f32 v45, v109, v31, v30
    v_exp_f32 v44, v44
    v_exp_f32 v45, v45
    v_add_f32 v32, v32, v44
    v_add_f32 v33, v33, v45
    v_cvt_pk_bf16_f32 v126, v44, v45
    v_fma_f32 v46, v110, v31, v30
    v_fma_f32 v47, v111, v31, v30
    v_mfma_f32_32x32x16_bf16 v[96:111], v[208:211], v[48:51], 0
    v_exp_f32 v46, v46
    v_exp_f32 v47, v47
    v_add_f32 v32, v32, v46
    v_add_f32 v33, v33, v47
    s_waitcnt lgkmcnt(0)
    v_mfma_f32_32x32x16_bf16 v[96:111], v[212:215], v[52:55], v[96:111]
    v_cvt_pk_bf16_f32 v127, v46, v47
    v_fma_f32 v40, v80, v31, v30
    v_fma_f32 v41, v81, v31, v30
    v_exp_f32 v40, v40
    v_mfma_f32_32x32x16_bf16 v[96:111], v[216:219], v[56:59], v[96:111]
    v_exp_f32 v41, v41
    v_add_f32 v32, v32, v40
    v_add_f32 v33, v33, v41
    v_cvt_pk_bf16_f32 v128, v40, v41
    v_fma_f32 v42, v82, v31, v30
    v_mfma_f32_32x32x16_bf16 v[96:111], v[220:223], v[60:63], v[96:111]
    v_fma_f32 v43, v83, v31, v30
    v_exp_f32 v42, v42
    v_exp_f32 v43, v43
    v_add_f32 v32, v32, v42
    v_mfma_f32_32x32x16_bf16 v[96:111], v[224:227], v[64:67], v[96:111]
    v_add_f32 v33, v33, v43
    v_cvt_pk_bf16_f32 v129, v42, v43
    v_fma_f32 v44, v84, v31, v30
    v_fma_f32 v45, v85, v31, v30
    v_exp_f32 v44, v44
    v_mfma_f32_32x32x16_bf16 v[96:111], v[228:231], v[68:71], v[96:111]
    v_exp_f32 v45, v45
    v_add_f32 v32, v32, v44
    v_add_f32 v33, v33, v45
    v_cvt_pk_bf16_f32 v130, v44, v45
    v_fma_f32 v46, v86, v31, v30
    v_mfma_f32_32x32x16_bf16 v[96:111], v[232:235], v[72:75], v[96:111]
    s_cbranch_scc1 L_nb8
    s_barrier
L_nb8:
    ds_read_b128 v[240:243], v8 offset:32768
    ds_read_b128 v[244:247], v9 offset:32768
    ds_read_b128 v[248:251], v10 offset:32768
    ds_read_b128 v[252:255], v11 offset:32768
    v_mfma_f32_32x32x16_bf16 v[96:111], v[236:239], v[76:79], v[96:111]
    ds_read_b128 v[208:211], v12 offset:32768
    ds_read_b128 v[212:215], v13 offset:32768
    ds_read_b128 v[216:219], v14 offset:32768
    ds_read_b128 v[220:223], v15 offset:32768
    v_fma_f32 v47, v87, v31, v30
    v_exp_f32 v46, v46
    v_exp_f32 v47, v47
    v_add_f32 v32, v32, v46
    v_add_f32 v33, v33, v47
    v_cvt_pk_bf16_f32 v131, v46, v47
    v_fma_f32 v40, v88, v31, v30
    v_fma_f32 v41, v89, v31, v30
    v_exp_f32 v40, v40
    v_exp_f32 v41, v41
    v_add_f32 v32, v32, v40
    v_add_f32 v33, v33, v41
    v_cvt_pk_bf16_f32 v132, v40, v41
    v_fma_f32 v42, v90, v31, v30
    v_fma_f32 v43, v91, v31, v30
    v_exp_f32 v42, v42
    v_exp_f32 v43, v43
    v_add_f32 v32, v32, v42
    v_add_f32 v33, v33, v43
    v_cvt_pk_bf16_f32 v133, v42, v43
    v_fma_f32 v44, v92, v31, v30
    v_fma_f32 v45, v93, v31, v30
    v_exp_f32 v44, v44
    v_exp_f32 v45, v45
    v_add_f32 v32, v32, v44
    v_add_f32 v33, v33, v45
    v_cvt_pk_bf16_f32 v134, v44, v45
    v_fma_f32 v46, v94, v31, v30
    v_fma_f32 v47, v95, v31, v30
    s_waitcnt lgkmcnt(3)
    v_mfma_f32_32x32x16_bf16 v[80:95], v[240:243], v[48:51], 0
    ds_read_b128 v[224:227], v8 offset:40960
    ds_read_b128 v[228:231], v9 offset:40960
    v_exp_f32 v46, v46
    v_exp_f32 v47, v47
    v_mfma_f32_32x32x16_bf16 v[80:95], v[244:247], v[52:55], v[80:95]
    ds_read_b128 v[232:235], v10 offset:40960
    ds_read_b128 v[236:239], v11 offset:40960
    v_add_f32 v32, v32, v46
    v_add_f32 v33, v33, v47
    v_cvt_pk_bf16_f32 v135, v46, v47
    v_fma_f32 v40, v96, v31, v30
    v_mfma_f32_32x32x16_bf16 v[80:95], v[248:251], v[56:59], v[80:95]
    ds_read_b128 v[240:243], v12 offset:40960
    ds_read_b128 v[244:247], v13 offset:40960
    s_cbranch_scc0 L_lg1
    s_barrier
L_lg1:
    v_mfma_f32_32x32x16_bf16 v[80:95], v[252:255], v[60:63], v[80:95]
    ds_read_b128 v[248:251], v14 offset:40960
    ds_read_b128 v[252:255], v15 offset:40960
    v_fma_f32 v41, v97, v31, v30
    v_exp_f32 v40, v40
    v_mfma_f32_32x32x16_bf16 v[80:95], v[208:211], v[64:67], v[80:95]
    ds_read_b128 v[208:211], v8 offset:49152
    v_exp_f32 v41, v41
    v_add_f32 v32, v32, v40
    v_add_f32 v33, v33, v41
    v_cvt_pk_bf16_f32 v136, v40, v41
    s_waitcnt lgkmcnt(9)
    v_mfma_f32_32x32x16_bf16 v[80:95], v[212:215], v[68:71], v[80:95]
    ds_read_b128 v[212:215], v9 offset:49152
    v_fma_f32 v42, v98, v31, v30
    v_fma_f32 v43, v99, v31, v30
    v_exp_f32 v42, v42
    v_mfma_f32_32x32x16_bf16 v[80:95], v[216:219], v[72:75], v[80:95]
    ds_read_b128 v[216:219], v10 offset:49152
    v_exp_f32 v43, v43
    v_add_f32 v32, v32, v42
    v_add_f32 v33, v33, v43
    v_cvt_pk_bf16_f32 v137, v42, v43
    v_mfma_f32_32x32x16_bf16 v[80:95], v[220:223], v[76:79], v[80:95]
    ds_read_b128 v[220:223], v11 offset:49152
    v_fma_f32 v44, v100, v31, v30
    v_fma_f32 v45, v101, v31, v30
    v_exp_f32 v44, v44
    v_exp_f32 v45, v45
    v_add_f32 v32, v32, v44
    v_add_f32 v33, v33, v45
    v_cvt_pk_bf16_f32 v138, v44, v45
    v_fma_f32 v46, v102, v31, v30
    v_fma_f32 v47, v103, v31, v30
    v_exp_f32 v46, v46
    v_exp_f32 v47, v47
    v_add_f32 v32, v32, v46
    v_add_f32 v33, v33, v47
    v_cvt_pk_bf16_f32 v139, v46, v47
    v_fma_f32 v40, v104, v31, v30
    v_fma_f32 v41, v105, v31, v30
    v_exp_f32 v40, v40
    v_exp_f32 v41, v41
    v_add_f32 v32, v32, v40
    v_add_f32 v33, v33, v41
    v_cvt_pk_bf16_f32 v140, v40, v41
    v_fma_f32 v42, v106, v31, v30
    v_fma_f32 v43, v107, v31, v30
    v_exp_f32 v42, v42
    v_exp_f32 v43, v43
    v_add_f32 v32, v32, v42
    v_add_f32 v33, v33, v43
    v_cvt_pk_bf16_f32 v141, v42, v43
    v_fma_f32 v44, v108, v31, v30
    v_fma_f32 v45, v109, v31, v30
    v_exp_f32 v44, v44
    v_exp_f32 v45, v45
    v_add_f32 v32, v32, v44
    v_add_f32 v33, v33, v45
    v_cvt_pk_bf16_f32 v142, v44, v45
    v_fma_f32 v46, v110, v31, v30
    v_fma_f32 v47, v111, v31, v30
    s_waitcnt lgkmcnt(0)
    v_mfma_f32_32x32x16_bf16 v[96:111], v[224:227], v[48:51], 0
    ds_read_b128 v[224:227], v12 offset:49152
    v_exp_f32 v46, v46
    v_exp_f32 v47, v47
    v_add_f32 v32, v32, v46
    v_mfma_f32_32x32x16_bf16 v[96:111], v[228:231], v[52:55], v[96:111]
    ds_read_b128 v[228:231], v13 offset:49152
    v_add_f32 v33, v33, v47
    v_cvt_pk_bf16_f32 v143, v46, v47
    v_fma_f32 v40, v80, v31, v30
    v_fma_f32 v41, v81, v31, v30
    v_mfma_f32_32x32x16_bf16 v[96:111], v[232:235], v[56:59], v[96:111]
    ds_read_b128 v[232:235], v14 offset:49152
    s_cbranch_scc0 L_lg2
    s_barrier
L_lg2:
    v_mfma_f32_32x32x16_bf16 v[96:111], v[236:239], v[60:63], v[96:111]
    ds_read_b128 v[236:239], v15 offset:49152
    v_exp_f32 v40, v40
    v_exp_f32 v41, v41
    v_add_f32 v32, v32, v40
    v_mfma_f32_32x32x16_bf16 v[96:111], v[240:243], v[64:67], v[96:111]
    ds_read_b128 v[240:243], v8 offset:57344
    v_add_f32 v33, v33, v41
    v_cvt_pk_bf16_f32 v144, v40, v41
    v_fma_f32 v42, v82, v31, v30
    v_fma_f32 v43, v83, v31, v30
    v_mfma_f32_32x32x16_bf16 v[96:111], v[244:247], v[68:71], v[96:111]
    ds_read_b128 v[244:247], v9 offset:57344
    v_exp_f32 v42, v42
    v_exp_f32 v43, v43
    v_add_f32 v32, v32, v42
    v_mfma_f32_32x32x16_bf16 v[96:111], v[248:251], v[72:75], v[96:111]
    ds_read_b128 v[248:251], v10 offset:57344
    v_add_f32 v33, v33, v43
    v_cvt_pk_bf16_f32 v145, v42, v43
    v_fma_f32 v44, v84, v31, v30
    v_fma_f32 v45, v85, v31, v30
    v_mfma_f32_32x32x16_bf16 v[96:111], v[252:255], v[76:79], v[96:111]
    ds_read_b128 v[252:255], v11 offset:57344
    v_exp_f32 v44, v44
    v_exp_f32 v45, v45
    v_add_f32 v32, v32, v44
    v_add_f32 v33, v33, v45
    v_cvt_pk_bf16_f32 v146, v44, v45
    v_fma_f32 v46, v86, v31, v30
    v_fma_f32 v47, v87, v31, v30
    v_exp_f32 v46, v46
    v_exp_f32 v47, v47
    v_add_f32 v32, v32, v46
    v_add_f32 v33, v33, v47
    v_cvt_pk_bf16_f32 v147, v46, v47
    v_fma_f32 v40, v88, v31, v30
    v_fma_f32 v41, v89, v31, v30
    v_exp_f32 v40, v40
    v_exp_f32 v41, v41
    v_add_f32 v32, v32, v40
    v_add_f32 v33, v33, v41
    v_cvt_pk_bf16_f32 v148, v40, v41
    v_fma_f32 v42, v90, v31, v30
    v_fma_f32 v43, v91, v31, v30
    v_exp_f32 v42, v42
    v_exp_f32 v43, v43
    v_add_f32 v32, v32, v42
    v_add_f32 v33, v33, v43
    v_cvt_pk_bf16_f32 v149, v42, v43
    v_fma_f32 v44, v92, v31, v30
    v_fma_f32 v45, v93, v31, v30
    v_exp_f32 v44, v44
    v_exp_f32 v45, v45
    v_add_f32 v32, v32, v44
    v_add_f32 v33, v33, v45
    v_cvt_pk_bf16_f32 v150, v44, v45
    v_fma_f32 v46, v94, v31, v30
    v_fma_f32 v47, v95, v31, v30
    v_mfma_f32_32x32x16_bf16 v[80:95], v[208:211], v[48:51], 0
    ds_read_b128 v[208:211], v12 offset:57344
    v_exp_f32 v46, v46
    v_exp_f32 v47, v47
    v_add_f32 v32, v32, v46
    v_mfma_f32_32x32x16_bf16 v[80:95], v[212:215], v[52:55], v[80:95]
    ds_read_b128 v[212:215], v13 offset:57344
    v_add_f32 v33, v33, v47
    v_cvt_pk_bf16_f32 v151, v46, v47
    v_fma_f32 v40, v96, v31, v30
    v_fma_f32 v41, v97, v31, v30
    v_mfma_f32_32x32x16_bf16 v[80:95], v[216:219], v[56:59], v[80:95]
    ds_read_b128 v[216:219], v14 offset:57344
    v_exp_f32 v40, v40
    v_exp_f32 v41, v41
    v_add_f32 v32, v32, v40
    v_mfma_f32_32x32x16_bf16 v[80:95], v[220:223], v[60:63], v[80:95]
    ds_read_b128 v[220:223], v15 offset:57344
    v_add_f32 v33, v33, v41
    v_cvt_pk_bf16_f32 v152, v40, v41
    v_fma_f32 v42, v98, v31, v30
    v_fma_f32 v43, v99, v31, v30
    s_waitcnt lgkmcnt(4)
    v_mfma_f32_32x32x16_bf16 v[80:95], v[224:227], v[64:67], v[80:95]
    v_exp_f32 v42, v42
    v_exp_f32 v43, v43
    v_add_f32 v32, v32, v42
    v_add_f32 v33, v33, v43
    v_mfma_f32_32x32x16_bf16 v[80:95], v[228:231], v[68:71], v[80:95]
    v_cvt_pk_bf16_f32 v153, v42, v43
    v_fma_f32 v44, v100, v31, v30
    v_fma_f32 v45, v101, v31, v30
    v_exp_f32 v44, v44
    v_mfma_f32_32x32x16_bf16 v[80:95], v[232:235], v[72:75], v[80:95]
    v_exp_f32 v45, v45
    v_add_f32 v32, v32, v44
    v_add_f32 v33, v33, v45
    v_cvt_pk_bf16_f32 v154, v44, v45
    v_fma_f32 v46, v102, v31, v30
    v_mfma_f32_32x32x16_bf16 v[80:95], v[236:239], v[76:79], v[80:95]
    v_fma_f32 v47, v103, v31, v30
    v_exp_f32 v46, v46
    v_exp_f32 v47, v47
    v_add_f32 v32, v32, v46
    v_add_f32 v33, v33, v47
    v_cvt_pk_bf16_f32 v155, v46, v47
    v_fma_f32 v40, v104, v31, v30
    v_fma_f32 v41, v105, v31, v30
    v_exp_f32 v40, v40
    v_exp_f32 v41, v41
    v_add_f32 v32, v32, v40
    v_add_f32 v33, v33, v41
    v_cvt_pk_bf16_f32 v156, v40, v41
    v_fma_f32 v42, v106, v31, v30
    v_fma_f32 v43, v107, v31, v30
    v_exp_f32 v42, v42
    v_exp_f32 v43, v43
    v_add_f32 v32, v32, v42
    v_add_f32 v33, v33, v43
    v_cvt_pk_bf16_f32 v157, v42, v43
    v_fma_f32 v44, v108, v31, v30
    v_fma_f32 v45, v109, v31, v30
    v_exp_f32 v44, v44
    v_exp_f32 v45, v45
    v_add_f32 v32, v32, v44
    v_add_f32 v33, v33, v45
    v_cvt_pk_bf16_f32 v158, v44, v45
    v_fma_f32 v46, v110, v31, v30
    v_fma_f32 v47, v111, v31, v30
    v_mfma_f32_32x32x16_bf16 v[96:111], v[240:243], v[48:51], 0
    v_exp_f32 v46, v46
    v_exp_f32 v47, v47
    v_add_f32 v32, v32, v46
    v_add_f32 v33, v33, v47
    v_mfma_f32_32x32x16_bf16 v[96:111], v[244:247], v[52:55], v[96:111]
    v_cvt_pk_bf16_f32 v159, v46, v47
    v_fma_f32 v40, v80, v31, v30
    v_fma_f32 v41, v81, v31, v30
    v_exp_f32 v40, v40
    v_mfma_f32_32x32x16_bf16 v[96:111], v[248:251], v[56:59], v[96:111]
    v_exp_f32 v41, v41
    v_add_f32 v32, v32, v40
    v_add_f32 v33, v33, v41
    v_cvt_pk_bf16_f32 v160, v40, v41
    v_fma_f32 v42, v82, v31, v30
    v_mfma_f32_32x32x16_bf16 v[96:111], v[252:255], v[60:63], v[96:111]
    s_cbranch_scc1 L_nb16
    s_barrier
L_nb16:
    ds_read_b64_tr_b16 v[224:225], v16 offset:0
    ds_read_b64_tr_b16 v[226:227], v16 offset:2048
    ds_read_b64_tr_b16 v[228:229], v16 offset:4096
    ds_read_b64_tr_b16 v[230:231], v16 offset:6144
    s_waitcnt lgkmcnt(4)
    v_mfma_f32_32x32x16_bf16 v[96:111], v[208:211], v[64:67], v[96:111]
    ds_read_b64_tr_b16 v[232:233], v16 offset:8192
    ds_read_b64_tr_b16 v[234:235], v16 offset:10240
    ds_read_b64_tr_b16 v[236:237], v16 offset:12288
    ds_read_b64_tr_b16 v[238:239], v16 offset:14336
    v_fma_f32 v43, v83, v31, v30
    v_mfma_f32_32x32x16_bf16 v[96:111], v[212:215], v[68:71], v[96:111]
    ds_read_b64_tr_b16 v[240:241], v16 offset:16384
    ds_read_b64_tr_b16 v[242:243], v16 offset:18432
    ds_read_b64_tr_b16 v[244:245], v16 offset:20480
    ds_read_b64_tr_b16 v[246:247], v16 offset:22528
    v_exp_f32 v42, v42
    v_mfma_f32_32x32x16_bf16 v[96:111], v[216:219], v[72:75], v[96:111]
    ds_read_b64_tr_b16 v[248:249], v16 offset:24576
    ds_read_b64_tr_b16 v[250:251], v16 offset:26624
    v_exp_f32 v43, v43
    v_add_f32 v32, v32, v42
    v_add_f32 v33, v33, v43
    v_mfma_f32_32x32x16_bf16 v[96:111], v[220:223], v[76:79], v[96:111]
    ds_read_b64_tr_b16 v[252:253], v16 offset:28672
    ds_read_b64_tr_b16 v[254:255], v16 offset:30720
    v_cvt_pk_bf16_f32 v161, v42, v43
    v_fma_f32 v44, v84, v31, v30
    v_fma_f32 v45, v85, v31, v30
    s_waitcnt lgkmcnt(14)
    v_mfma_f32_32x32x16_bf16 v[176:191], v[224:227], v[112:115], 0
    ds_read_b64_tr_b16 v[208:209], v16 offset:32768
    ds_read_b64_tr_b16 v[210:211], v16 offset:34816
    v_exp_f32 v44, v44
    v_exp_f32 v45, v45
    s_waitcnt lgkmcnt(14)
    v_mfma_f32_32x32x16_bf16 v[176:191], v[228:231], v[116:119], v[176:191]
    ds_read_b64_tr_b16 v[212:213], v16 offset:36864
    ds_read_b64_tr_b16 v[214:215], v16 offset:38912
    v_add_f32 v32, v32, v44
    v_add_f32 v33, v33, v45
    v_cvt_pk_bf16_f32 v162, v44, v45
    v_fma_f32 v46, v86, v31, v30
    s_waitcnt lgkmcnt(12)
    v_mfma_f32_32x32x16_bf16 v[176:191], v[232:235], v[120:123], v[176:191]
    ds_read_b64_tr_b16 v[216:217], v16 offset:40960
    ds_read_b64_tr_b16 v[218:219], v16 offset:43008
    v_fma_f32 v47, v87, v31, v30
    v_exp_f32 v46, v46
    v_mfma_f32_32x32x16_bf16 v[176:191], v[236:239], v[124:127], v[176:191]
    ds_read_b64_tr_b16 v[220:221], v16 offset:45056
    ds_read_b64_tr_b16 v[222:223], v16 offset:47104
    v_exp_f32 v47, v47
    v_add_f32 v32, v32, v46
    v_add_f32 v33, v33, v47
    s_waitcnt lgkmcnt(10)
    v_mfma_f32_32x32x16_bf16 v[176:191], v[240:243], v[128:131], v[176:191]
    ds_read_b64_tr_b16 v[224:225], v16 offset:49152
    ds_read_b64_tr_b16 v[226:227], v16 offset:51200
    v_cvt_pk_bf16_f32 v163, v46, v47
    v_fma_f32 v40, v88, v31, v30
    v_fma_f32 v41, v89, v31, v30
    v_mfma_f32_32x32x16_bf16 v[176:191], v[244:247], v[132:135], v[176:191]
    ds_read_b64_tr_b16 v[228:229], v16 offset:53248
    ds_read_b64_tr_b16 v[230:231], v16 offset:55296
    v_exp_f32 v40, v40
    v_exp_f32 v41, v41
    v_mfma_f32_32x32x16_bf16 v[176:191], v[248:251], v[136:139], v[176:191]
    ds_read_b64_tr_b16 v[232:233], v17 offset:0
    ds_read_b64_tr_b16 v[234:235], v17 offset:2048
    s_cbranch_scc1 L_ld6
    s_barrier
L_ld6:
    s_waitcnt lgkmcnt(10)
    v_mfma_f32_32x32x16_bf16 v[176:191], v[252:255], v[140:143], v[176:191]
    ds_read_b64_tr_b16 v[236:237], v17 offset:4096
    ds_read_b64_tr_b16 v[238:239], v17 offset:6144
    v_add_f32 v32, v32, v40
    v_add_f32 v33, v33, v41
    v_cvt_pk_bf16_f32 v164, v40, v41
    v_fma_f32 v42, v90, v31, v30
    v_mfma_f32_32x32x16_bf16 v[176:191], v[208:211], v[144:147], v[176:191]
    ds_read_b64_tr_b16 v[240:241], v17 offset:8192
    ds_read_b64_tr_b16 v[242:243], v17 offset:10240
    v_fma_f32 v43, v91, v31, v30
    v_exp_f32 v42, v42
    v_mfma_f32_32x32x16_bf16 v[176:191], v[212:215], v[148:151], v[176:191]
    ds_read_b64_tr_b16 v[244:245], v17 offset:12288
    ds_read_b64_tr_b16 v[246:247], v17 offset:14336
    v_exp_f32 v43, v43
    v_add_f32 v32, v32, v42
    v_add_f32 v33, v33, v43
    s_waitcnt lgkmcnt(10)
    v_mfma_f32_32x32x16_bf16 v[176:191], v[216:219], v[152:155], v[176:191]
    ds_read_b64_tr_b16 v[248:249], v17 offset:16384
    ds_read_b64_tr_b16 v[250:251], v17 offset:18432
    v_cvt_pk_bf16_f32 v165, v42, v43
    v_fma_f32 v44, v92, v31, v30
    v_fma_f32 v45, v93, v31, v30
    v_mfma_f32_32x32x16_bf16 v[176:191], v[220:223], v[156:159], v[176:191]
    ds_read_b64_tr_b16 v[252:253], v17 offset:20480
    ds_read_b64_tr_b16 v[254:255], v17 offset:22528
    v_exp_f32 v44, v44
    v_exp_f32 v45, v45
    v_mfma_f32_32x32x16_bf16 v[176:191], v[224:227], v[160:163], v[176:191]
    ds_read_b64_tr_b16 v[208:209], v16 offset:57344
    ds_read_b64_tr_b16 v[210:211], v16 offset:59392
    v_add_f32 v32, v32, v44
    v_add_f32 v33, v33, v45
    v_cvt_pk_bf16_f32 v166, v44, v45
    v_fma_f32 v46, v94, v31, v30
    v_fma_f32 v47, v95, v31, v30
    v_exp_f32 v46, v46
    v_exp_f32 v47, v47
    v_add_f32 v32, v32, v46
    v_add_f32 v33, v33, v47
    v_cvt_pk_bf16_f32 v167, v46, v47
    v_fma_f32 v40, v96, v31, v30
    v_fma_f32 v41, v97, v31, v30
    s_waitcnt lgkmcnt(7)
    v_mfma_f32_32x32x16_bf16 v[176:191], v[228:231], v[164:167], v[176:191]
    ds_read_b64_tr_b16 v[212:213], v17 offset:24576
    ds_read_b64_tr_b16 v[214:215], v17 offset:26624
    v_exp_f32 v40, v40
    v_exp_f32 v41, v41
    v_mfma_f32_32x32x16_bf16 v[192:207], v[232:235], v[112:115], 0
    ds_read_b64_tr_b16 v[216:217], v17 offset:28672
    ds_read_b64_tr_b16 v[218:219], v17 offset:30720
    v_add_f32 v32, v32, v40
    v_add_f32 v33, v33, v41
    v_cvt_pk_bf16_f32 v168, v40, v41
    v_fma_f32 v42, v98, v31, v30
    v_mfma_f32_32x32x16_bf16 v[192:207], v[236:239], v[116:119], v[192:207]
    ds_read_b64_tr_b16 v[220:221], v17 offset:32768
    ds_read_b64_tr_b16 v[222:223], v17 offset:34816
    v_fma_f32 v43, v99, v31, v30
    v_exp_f32 v42, v42
    v_mfma_f32_32x32x16_bf16 v[192:207], v[240:243], v[120:123], v[192:207]
    ds_read_b64_tr_b16 v[224:225], v17 offset:36864
    ds_read_b64_tr_b16 v[226:227], v17 offset:38912
    v_exp_f32 v43, v43
    v_add_f32 v32, v32, v42
    v_add_f32 v33, v33, v43
    s_waitcnt lgkmcnt(8)
    v_mfma_f32_32x32x16_bf16 v[192:207], v[244:247], v[124:127], v[192:207]
    ds_read_b64_tr_b16 v[228:229], v17 offset:40960
    ds_read_b64_tr_b16 v[230:231], v17 offset:43008
    v_cvt_pk_bf16_f32 v169, v42, v43
    v_fma_f32 v44, v100, v31, v30
    v_fma_f32 v45, v101, v31, v30
    v_mfma_f32_32x32x16_bf16 v[192:207], v[248:251], v[128:131], v[192:207]
    ds_read_b64_tr_b16 v[232:233], v17 offset:45056
    ds_read_b64_tr_b16 v[234:235], v17 offset:47104
    v_exp_f32 v44, v44
    v_exp_f32 v45, v45
    v_mfma_f32_32x32x16_bf16 v[192:207], v[252:255], v[132:135], v[192:207]
    ds_read_b64_tr_b16 v[236:237], v16 offset:61440
    ds_read_b64_tr_b16 v[238:239], v16 offset:63488
    v_add_f32 v32, v32, v44
    v_add_f32 v33, v33, v45
    v_cvt_pk_bf16_f32 v170, v44, v45
    v_fma_f32 v46, v102, v31, v30
    v_fma_f32 v47, v103, v31, v30
    v_exp_f32 v46, v46
    v_exp_f32 v47, v47
    v_add_f32 v32, v32, v46
    v_add_f32 v33, v33, v47
    v_cvt_pk_bf16_f32 v171, v46, v47
    v_fma_f32 v40, v104, v31, v30
    v_fma_f32 v41, v105, v31, v30
    v_mfma_f32_32x32x16_bf16 v[176:191], v[208:211], v[168:171], v[176:191]
    ds_read_b64_tr_b16 v[240:241], v17 offset:49152
    ds_read_b64_tr_b16 v[242:243], v17 offset:51200
    v_exp_f32 v40, v40
    v_exp_f32 v41, v41
    s_waitcnt lgkmcnt(8)
    v_mfma_f32_32x32x16_bf16 v[192:207], v[212:215], v[136:139], v[192:207]
    ds_read_b64_tr_b16 v[244:245], v17 offset:53248
    ds_read_b64_tr_b16 v[246:247], v17 offset:55296
    v_add_f32 v32, v32, v40
    v_add_f32 v33, v33, v41
    v_cvt_pk_bf16_f32 v172, v40, v41
    v_fma_f32 v42, v106, v31, v30
    v_mfma_f32_32x32x16_bf16 v[192:207], v[216:219], v[140:143], v[192:207]
    ds_read_b64_tr_b16 v[248:249], v17 offset:57344
    ds_read_b64_tr_b16 v[250:251], v17 offset:59392
    v_fma_f32 v43, v107, v31, v30
    v_exp_f32 v42, v42
    v_mfma_f32_32x32x16_bf16 v[192:207], v[220:223], v[144:147], v[192:207]
    ds_read_b64_tr_b16 v[252:253], v17 offset:61440
    ds_read_b64_tr_b16 v[254:255], v17 offset:63488
    v_exp_f32 v43, v43
    v_add_f32 v32, v32, v42
    v_add_f32 v33, v33, v43
    v_mfma_f32_32x32x16_bf16 v[192:207], v[224:227], v[148:151], v[192:207]
    ds_read_b64_tr_b16 v[208:209], v18 offset:0
    ds_read_b64_tr_b16 v[210:211], v18 offset:2048
    v_cvt_pk_bf16_f32 v173, v42, v43
    v_fma_f32 v44, v108, v31, v30
    v_fma_f32 v45, v109, v31, v30
    s_waitcnt lgkmcnt(10)
    v_mfma_f32_32x32x16_bf16 v[192:207], v[228:231], v[152:155], v[192:207]
    ds_read_b64_tr_b16 v[212:213], v18 offset:4096
    ds_read_b64_tr_b16 v[214:215], v18 offset:6144
    v_exp_f32 v44, v44
    v_exp_f32 v45, v45
    v_mfma_f32_32x32x16_bf16 v[192:207], v[232:235], v[156:159], v[192:207]
    ds_read_b64_tr_b16 v[216:217], v18 offset:8192
    ds_read_b64_tr_b16 v[218:219], v18 offset:10240
    v_add_f32 v32, v32, v44
    v_add_f32 v33, v33, v45
    v_cvt_pk_bf16_f32 v174, v44, v45
    v_fma_f32 v46, v110, v31, v30
    v_fma_f32 v47, v111, v31, v30
    v_exp_f32 v46, v46
    v_exp_f32 v47, v47
    v_add_f32 v32, v32, v46
    v_cvt_pk_bf16_f32 v175, v46, v47
    v_add_f32 v33, v33, v47
    v_add_f32 v32, v32, v33
    v_mfma_f32_32x32x16_bf16 v[176:191], v[236:239], v[172:175], v[176:191]
    ds_read_b64_tr_b16 v[220:221], v18 offset:12288
    ds_read_b64_tr_b16 v[222:223], v18 offset:14336
    v_mov_b32 v33, v32
    s_waitcnt lgkmcnt(8)
    v_mfma_f32_32x32x16_bf16 v[192:207], v[240:243], v[160:163], v[192:207]
    ds_read_b64_tr_b16 v[224:225], v18 offset:16384
    ds_read_b64_tr_b16 v[226:227], v18 offset:18432
    v_permlane32_swap_b32 v32, v33
    v_add_f32 v32, v32, v33
    v_cmp_lt_f32 vcc, v6, v32
    v_mfma_f32_32x32x16_bf16 v[192:207], v[244:247], v[164:167], v[192:207]
    ds_read_b64_tr_b16 v[228:229], v18 offset:20480
    ds_read_b64_tr_b16 v[230:231], v18 offset:22528
    v_rcp_f32 v35, v32
    v_xor_b32 v21, 32, v24
    v_xor_b32 v22, 64, v24
    v_mfma_f32_32x32x16_bf16 v[192:207], v[248:251], v[168:171], v[192:207]
    ds_read_b64_tr_b16 v[232:233], v18 offset:24576
    ds_read_b64_tr_b16 v[234:235], v18 offset:26624
    v_xor_b32 v23, 96, v24
    s_cbranch_vccnz L_fb
    v_mul_f32 v176, v35, v176
    v_mul_f32 v177, v35, v177
    v_mfma_f32_32x32x16_bf16 v[192:207], v[252:255], v[172:175], v[192:207]
    ds_read_b64_tr_b16 v[236:237], v18 offset:28672
    ds_read_b64_tr_b16 v[238:239], v18 offset:30720
    v_mul_f32 v178, v35, v178
    v_mul_f32 v179, v35, v179
    v_mul_f32 v180, v35, v180
    v_mul_f32 v181, v35, v181
    s_waitcnt lgkmcnt(10)
    v_mfma_f32_32x32x16_bf16 v[48:63], v[208:211], v[112:115], 0
    ds_read_b64_tr_b16 v[240:241], v18 offset:32768
    ds_read_b64_tr_b16 v[242:243], v18 offset:34816
    v_mul_f32 v182, v35, v182
    v_mul_f32 v183, v35, v183
    v_cvt_pk_bf16_f32 v176, v176, v177
    v_cvt_pk_bf16_f32 v177, v178, v179
    v_mfma_f32_32x32x16_bf16 v[48:63], v[212:215], v[116:119], v[48:63]
    ds_read_b64_tr_b16 v[244:245], v18 offset:36864
    ds_read_b64_tr_b16 v[246:247], v18 offset:38912
    v_cvt_pk_bf16_f32 v178, v180, v181
    v_cvt_pk_bf16_f32 v179, v182, v183
    v_mul_f32 v184, v35, v184
    v_mul_f32 v185, v35, v185
    v_mfma_f32_32x32x16_bf16 v[48:63], v[216:219], v[120:123], v[48:63]
    ds_read_b64_tr_b16 v[248:249], v18 offset:40960
    ds_read_b64_tr_b16 v[250:251], v18 offset:43008
    ds_write_b128 v24, v[176:179]
    v_mul_f32 v186, v35, v186
    v_mul_f32 v187, v35, v187
    v_mul_f32 v188, v35, v188
    s_waitcnt lgkmcnt(11)
    v_mfma_f32_32x32x16_bf16 v[48:63], v[220:223], v[124:127], v[48:63]
    v_mul_f32 v189, v35, v189
    v_mul_f32 v190, v35, v190
    v_mul_f32 v191, v35, v191
    v_cvt_pk_bf16_f32 v180, v184, v185
    v_cvt_pk_bf16_f32 v181, v186, v187
    v_cvt_pk_bf16_f32 v182, v188, v189
    v_mfma_f32_32x32x16_bf16 v[48:63], v[224:227], v[128:131], v[48:63]
    ds_read_b64_tr_b16 v[252:253], v18 offset:45056
    ds_read_b64_tr_b16 v[254:255], v18 offset:47104
    ds_read_b64_tr_b16 v[208:209], v18 offset:49152
    ds_read_b64_tr_b16 v[210:211], v18 offset:51200
    v_cvt_pk_bf16_f32 v183, v190, v191
    v_mul_f32 v192, v35, v192
    v_mfma_f32_32x32x16_bf16 v[48:63], v[228:231], v[132:135], v[48:63]
    ds_read_b64_tr_b16 v[212:213], v18 offset:53248
    ds_read_b64_tr_b16 v[214:215], v18 offset:55296
    ds_write_b128 v21, v[180:183]
    v_mul_f32 v193, v35, v193
    v_mul_f32 v194, v35, v194
    v_mul_f32 v195, v35, v195
    s_waitcnt lgkmcnt(12)
    v_mfma_f32_32x32x16_bf16 v[48:63], v[232:235], v[136:139], v[48:63]
    v_mul_f32 v196, v35, v196
    v_mul_f32 v197, v35, v197
    v_mul_f32 v198, v35, v198
    v_mul_f32 v199, v35, v199
    v_cvt_pk_bf16_f32 v192, v192, v193
    v_cvt_pk_bf16_f32 v193, v194, v195
    v_mfma_f32_32x32x16_bf16 v[48:63], v[236:239], v[140:143], v[48:63]
    ds_read_b64_tr_b16 v[216:217], v18 offset:57344
    ds_read_b64_tr_b16 v[218:219], v18 offset:59392
    ds_read_b64_tr_b16 v[220:221], v18 offset:61440
    ds_read_b64_tr_b16 v[222:223], v18 offset:63488
    v_cvt_pk_bf16_f32 v194, v196, v197
    v_cvt_pk_bf16_f32 v195, v198, v199
    v_mfma_f32_32x32x16_bf16 v[48:63], v[240:243], v[144:147], v[48:63]
    ds_read_b64_tr_b16 v[224:225], v19 offset:0
    ds_read_b64_tr_b16 v[226:227], v19 offset:2048
    ds_write_b128 v22, v[192:195]
    v_mul_f32 v200, v35, v200
    v_mul_f32 v201, v35, v201
    v_mul_f32 v202, v35, v202
    s_waitcnt lgkmcnt(14)
    v_mfma_f32_32x32x16_bf16 v[48:63], v[244:247], v[148:151], v[48:63]
    v_mul_f32 v203, v35, v203
    v_mul_f32 v204, v35, v204
    v_mul_f32 v205, v35, v205
    v_mul_f32 v206, v35, v206
    v_mul_f32 v207, v35, v207
    v_cvt_pk_bf16_f32 v196, v200, v201
    v_mfma_f32_32x32x16_bf16 v[48:63], v[248:251], v[152:155], v[48:63]
    ds_read_b64_tr_b16 v[228:229], v19 offset:4096
    ds_read_b64_tr_b16 v[230:231], v19 offset:6144
    ds_read_b64_tr_b16 v[232:233], v19 offset:8192
    ds_read_b64_tr_b16 v[234:235], v19 offset:10240
    v_cvt_pk_bf16_f32 v197, v202, v203
    v_cvt_pk_bf16_f32 v198, v204, v205
    s_waitcnt lgkmcnt(11)
    v_mfma_f32_32x32x16_bf16 v[48:63], v[252:255], v[156:159], v[48:63]
    ds_read_b64_tr_b16 v[236:237], v19 offset:12288
    ds_read_b64_tr_b16 v[238:239], v19 offset:14336
    v_cvt_pk_bf16_f32 v199, v206, v207
    v_mfma_f32_32x32x16_bf16 v[48:63], v[208:211], v[160:163], v[48:63]
    ds_read_b64_tr_b16 v[240:241], v19 offset:16384
    ds_read_b64_tr_b16 v[242:243], v19 offset:18432
    ds_write_b128 v23, v[196:199]
    v_mfma_f32_32x32x16_bf16 v[48:63], v[212:215], v[164:167], v[48:63]
    s_waitcnt lgkmcnt(10)
    v_mfma_f32_32x32x16_bf16 v[48:63], v[216:219], v[168:171], v[48:63]
    ds_read_b64_tr_b16 v[244:245], v19 offset:20480
    ds_read_b64_tr_b16 v[246:247], v19 offset:22528
    ds_read_b64_tr_b16 v[248:249], v19 offset:24576
    ds_read_b64_tr_b16 v[250:251], v19 offset:26624
    v_mfma_f32_32x32x16_bf16 v[48:63], v[220:223], v[172:175], v[48:63]
    ds_read_b64_tr_b16 v[252:253], v19 offset:28672
    ds_read_b64_tr_b16 v[254:255], v19 offset:30720
    v_mfma_f32_32x32x16_bf16 v[64:79], v[224:227], v[112:115], 0
    ds_read_b64_tr_b16 v[208:209], v19 offset:32768
    ds_read_b64_tr_b16 v[210:211], v19 offset:34816
    s_waitcnt lgkmcnt(8)
    ds_read_b128 v[80:83], v26 offset:0
    ds_read_b128 v[84:87], v26 offset:1024
    ds_read_b128 v[88:91], v26 offset:2048
    v_mfma_f32_32x32x16_bf16 v[64:79], v[228:231], v[116:119], v[64:79]
    ds_read_b64_tr_b16 v[212:213], v19 offset:36864
    ds_read_b64_tr_b16 v[214:215], v19 offset:38912
    ds_read_b128 v[92:95], v26 offset:3072
    v_mul_f32 v48, v35, v48
    v_mul_f32 v49, v35, v49
    v_mul_f32 v50, v35, v50
    v_mfma_f32_32x32x16_bf16 v[64:79], v[232:235], v[120:123], v[64:79]
    ds_read_b64_tr_b16 v[216:217], v19 offset:40960
    ds_read_b64_tr_b16 v[218:219], v19 offset:43008
    v_mul_f32 v51, v35, v51
    v_mul_f32 v52, v35, v52
    v_mul_f32 v53, v35, v53
    v_mul_f32 v54, v35, v54
    v_mfma_f32_32x32x16_bf16 v[64:79], v[236:239], v[124:127], v[64:79]
    ds_read_b64_tr_b16 v[220:221], v19 offset:45056
    ds_read_b64_tr_b16 v[222:223], v19 offset:47104
    v_mul_f32 v55, v35, v55
    v_cvt_pk_bf16_f32 v48, v48, v49
    v_cvt_pk_bf16_f32 v49, v50, v51
    v_cvt_pk_bf16_f32 v50, v52, v53
    v_mfma_f32_32x32x16_bf16 v[64:79], v[240:243], v[128:131], v[64:79]
    ds_read_b64_tr_b16 v[224:225], v19 offset:49152
    ds_read_b64_tr_b16 v[226:227], v19 offset:51200
    v_cvt_pk_bf16_f32 v51, v54, v55
    v_mul_f32 v56, v35, v56
    v_mul_f32 v57, v35, v57
    v_mul_f32 v58, v35, v58
    s_waitcnt lgkmcnt(14)
    v_mfma_f32_32x32x16_bf16 v[64:79], v[244:247], v[132:135], v[64:79]
    ds_read_b64_tr_b16 v[228:229], v19 offset:53248
    ds_read_b64_tr_b16 v[230:231], v19 offset:55296
    s_waitcnt lgkmcnt(8)
    ds_write_b128 v24, v[48:51]
    v_mul_f32 v59, v35, v59
    v_mul_f32 v60, v35, v60
    v_mfma_f32_32x32x16_bf16 v[64:79], v[248:251], v[136:139], v[64:79]
    v_mul_f32 v61, v35, v61
    v_mul_f32 v62, v35, v62
    v_mul_f32 v63, v35, v63
    v_cvt_pk_bf16_f32 v52, v56, v57
    v_cvt_pk_bf16_f32 v53, v58, v59
    v_cvt_pk_bf16_f32 v54, v60, v61
    v_mfma_f32_32x32x16_bf16 v[64:79], v[252:255], v[140:143], v[64:79]
    ds_read_b64_tr_b16 v[232:233], v19 offset:57344
    ds_read_b64_tr_b16 v[234:235], v19 offset:59392
    ds_read_b64_tr_b16 v[236:237], v19 offset:61440
    ds_read_b64_tr_b16 v[238:239], v19 offset:63488
    v_cvt_pk_bf16_f32 v55, v62, v63
    v_mov_b32 v34, v35
    v_mfma_f32_32x32x16_bf16 v[64:79], v[208:211], v[144:147], v[64:79]
    ds_write_b128 v21, v[52:55]
    v_mfma_f32_32x32x16_bf16 v[64:79], v[212:215], v[148:151], v[64:79]
    s_waitcnt lgkmcnt(9)
    v_mfma_f32_32x32x16_bf16 v[64:79], v[216:219], v[152:155], v[64:79]
    v_mfma_f32_32x32x16_bf16 v[64:79], v[220:223], v[156:159], v[64:79]
    s_waitcnt lgkmcnt(5)
    v_mfma_f32_32x32x16_bf16 v[64:79], v[224:227], v[160:163], v[64:79]
    v_mfma_f32_32x32x16_bf16 v[64:79], v[228:231], v[164:167], v[64:79]
    s_waitcnt lgkmcnt(1)
    v_mfma_f32_32x32x16_bf16 v[64:79], v[232:235], v[168:171], v[64:79]
    v_mfma_f32_32x32x16_bf16 v[64:79], v[236:239], v[172:175], v[64:79]
    s_nop 11
    v_pk_mul_f32 v[64:65], v[34:35], v[64:65]
    v_pk_mul_f32 v[66:67], v[34:35], v[66:67]
    v_pk_mul_f32 v[68:69], v[34:35], v[68:69]
    v_pk_mul_f32 v[70:71], v[34:35], v[70:71]
    v_cvt_pk_bf16_f32 v64, v64, v65
    v_cvt_pk_bf16_f32 v65, v66, v67
    v_cvt_pk_bf16_f32 v66, v68, v69
    v_cvt_pk_bf16_f32 v67, v70, v71
    ds_write_b128 v22, v[64:67]
    v_pk_mul_f32 v[72:73], v[34:35], v[72:73]
    v_pk_mul_f32 v[74:75], v[34:35], v[74:75]
    v_pk_mul_f32 v[76:77], v[34:35], v[76:77]
    v_pk_mul_f32 v[78:79], v[34:35], v[78:79]
    v_cvt_pk_bf16_f32 v68, v72, v73
    v_cvt_pk_bf16_f32 v69, v74, v75
    v_cvt_pk_bf16_f32 v70, v76, v77
    v_cvt_pk_bf16_f32 v71, v78, v79
    ds_write_b128 v23, v[68:71]
    s_waitcnt lgkmcnt(0)
    ds_read_b128 v[96:99], v26 offset:0
    ds_read_b128 v[100:103], v26 offset:1024
    ds_read_b128 v[104:107], v26 offset:2048
    ds_read_b128 v[108:111], v26 offset:3072
    buffer_store_dwordx4 v[80:83], v27, s[28:31], s92 offen offset:0 sc1
    buffer_store_dwordx4 v[84:87], v27, s[28:31], s93 offen offset:0 sc1
    buffer_store_dwordx4 v[88:91], v27, s[28:31], s94 offen offset:0 sc1
    buffer_store_dwordx4 v[92:95], v27, s[28:31], s95 offen offset:0 sc1
    s_waitcnt lgkmcnt(3)
    buffer_store_dwordx4 v[96:99], v27, s[28:31], s92 offen offset:128 sc1
    s_waitcnt lgkmcnt(2)
    buffer_store_dwordx4 v[100:103], v27, s[28:31], s93 offen offset:128 sc1
    s_waitcnt lgkmcnt(1)
    buffer_store_dwordx4 v[104:107], v27, s[28:31], s94 offen offset:128 sc1
    s_waitcnt lgkmcnt(0)
    buffer_store_dwordx4 v[108:111], v27, s[28:31], s95 offen offset:128 sc1
L_fin:
L_end:
    s_endpgm
L_fb:
    s_waitcnt lgkmcnt(0)
    s_nop 15
    v_mov_b32 v6, 0x7f800000
    s_mov_b64 s[96:97], 0
    v_and_b32 v2, 31, v0
    v_lshrrev_b32 v3, 5, v0
    v_lshlrev_b32 v4, 8, v2
    v_lshl_add_u32 v4, v3, 4, v4
    buffer_load_dwordx4 v[48:51], v4, s[16:19], s34 offen offset:0
    buffer_load_dwordx4 v[52:55], v4, s[16:19], s34 offen offset:32
    buffer_load_dwordx4 v[56:59], v4, s[16:19], s34 offen offset:64
    buffer_load_dwordx4 v[60:63], v4, s[16:19], s34 offen offset:96
    buffer_load_dwordx4 v[64:67], v4, s[16:19], s34 offen offset:128
    buffer_load_dwordx4 v[68:71], v4, s[16:19], s34 offen offset:160
    buffer_load_dwordx4 v[72:75], v4, s[16:19], s34 offen offset:192
    buffer_load_dwordx4 v[76:79], v4, s[16:19], s34 offen offset:224
    s_mov_b32 s32, 0
    s_waitcnt vmcnt(0)
L_fbloop:
    ds_read_b128 v[208:211], v8
    ds_read_b128 v[212:215], v9
    ds_read_b128 v[216:219], v10
    ds_read_b128 v[220:223], v11
    ds_read_b128 v[224:227], v12
    ds_read_b128 v[228:231], v13
    ds_read_b128 v[232:235], v14
    ds_read_b128 v[236:239], v15
    s_waitcnt lgkmcnt(0)
    v_mfma_f32_32x32x16_bf16 v[80:95], v[208:211], v[48:51], 0
    v_mfma_f32_32x32x16_bf16 v[80:95], v[212:215], v[52:55], v[80:95]
    v_mfma_f32_32x32x16_bf16 v[80:95], v[216:219], v[56:59], v[80:95]
    v_mfma_f32_32x32x16_bf16 v[80:95], v[220:223], v[60:63], v[80:95]
    v_mfma_f32_32x32x16_bf16 v[80:95], v[224:227], v[64:67], v[80:95]
    v_mfma_f32_32x32x16_bf16 v[80:95], v[228:231], v[68:71], v[80:95]
    v_mfma_f32_32x32x16_bf16 v[80:95], v[232:235], v[72:75], v[80:95]
    v_mfma_f32_32x32x16_bf16 v[80:95], v[236:239], v[76:79], v[80:95]
    v_add_u32 v8, 0x2000, v8
    v_add_u32 v9, 0x2000, v9
    v_add_u32 v10, 0x2000, v10
    v_add_u32 v11, 0x2000, v11
    v_add_u32 v12, 0x2000, v12
    v_add_u32 v13, 0x2000, v13
    v_add_u32 v14, 0x2000, v14
    v_add_u32 v15, 0x2000, v15
    s_nop 7
    v_max3_f32 v34, v34, v80, v81
    v_max3_f32 v34, v34, v82, v83
    v_max3_f32 v34, v34, v84, v85
    v_max3_f32 v34, v34, v86, v87
    v_max3_f32 v34, v34, v88, v89
    v_max3_f32 v34, v34, v90, v91
    v_max3_f32 v34, v34, v92, v93
    v_max3_f32 v34, v34, v94, v95
    s_add_u32 s32, s32, 1
    s_cmp_lt_u32 s32, 8
    s_cbranch_scc1 L_fbloop
    v_subrev_u32 v8, 0x10000, v8
    v_subrev_u32 v9, 0x10000, v9
    v_subrev_u32 v10, 0x10000, v10
    v_subrev_u32 v11, 0x10000, v11
    v_subrev_u32 v12, 0x10000, v12
    v_subrev_u32 v13, 0x10000, v13
    v_subrev_u32 v14, 0x10000, v14
    v_subrev_u32 v15, 0x10000, v15
    v_lshrrev_b32 v4, 4, v0
    v_lshrrev_b32 v5, 2, v0
    v_xor_b32 v4, v4, v5
    v_and_b32 v4, 1, v4
    v_sub_u32 v4, v4, 1
    v_and_b32 v248, 0x3f803f80, v4
    v_and_b32 v249, 0x3f803f80, v4
    v_and_b32 v250, 0x3f803f80, v4
    v_and_b32 v251, 0x3f803f80, v4
    s_branch L_mainB
L_pad:
    .fill (16384 + 256 - (L_pad - standalone__gqa_softmax__near_ridge_kernel)) / 4, 4, 0xbf810000

.section .rodata,"a"
.p2align 6
.amdhsa_kernel standalone__gqa_softmax__near_ridge_kernel
  .amdhsa_next_free_vgpr 256
  .amdhsa_next_free_sgpr 102
  .amdhsa_accum_offset 256
  .amdhsa_group_segment_fixed_size 0
  .amdhsa_kernarg_size 48
  .amdhsa_user_sgpr_count 2
  .amdhsa_user_sgpr_kernarg_segment_ptr 1
  .amdhsa_system_sgpr_workgroup_id_x 1
.end_amdhsa_kernel
```
